```python
import torch

def _softmax(x, axis=-1):
    return torch.softmax(x, dim=axis)
def _gelu(x):
    return torch.nn.functional.gelu(x, approximate="tanh")
def _silu(x):
    return torch.nn.functional.silu(x)
def _sigmoid(x):
    return torch.sigmoid(x)
def _layernorm(x, axis=-1, eps=1e-5):
    m = x.mean(dim=axis, keepdim=True)
    v = x.var(dim=axis, keepdim=True, unbiased=False)
    return (x - m) / torch.sqrt(v + eps)
def _scatter_add(tgt, idx, src, axis=0):
    return tgt.clone().index_add_(axis, idx, src)
def _segment_sum(src, seg, n):
    out = torch.zeros((n,) + src.shape[1:], dtype=src.dtype)
    return out.index_add_(0, seg, src)
def _pad(x, pw):
    flat = tuple(v for pair in reversed(pw) for v in pair)
    return torch.nn.functional.pad(x, flat)

kernel_name = 'parallel_sum__sliding_block_cached__swiglu_ffn__decode'

def setup_inputs():

    _w = (lambda a: (lambda t: t.to(torch.bfloat16) if t.is_floating_point() else t)(torch.as_tensor(a)))
    def _A_setup():
        B, Sq, D = 1, 1, 576
        Hq, Hkv, Sk, Dh = 32, 16, 65536, 128
        assert Hq % Hkv == 0, (Hq, Hkv)
        return {
            "x": _w((lambda *s: torch.randn(*s, dtype=torch.bfloat16) * 0.05)(B, Sq, D)),
            "k_cache": _w((lambda *s: torch.randn(*s, dtype=torch.bfloat16) * 3.2)(B, Hkv, Sk, Dh)),
            "v_cache": _w((lambda *s: torch.randn(*s, dtype=torch.bfloat16) * 1.6)(B, Hkv, Sk, Dh)),
            "wq": _w((lambda *s: torch.randn(*s, dtype=torch.bfloat16) * 3.2)(D, Hq * Dh) * (D ** -0.5)),
            "wo": _w((lambda *s: torch.randn(*s, dtype=torch.bfloat16) * 1.6)(Hq * Dh, D) * ((Hq * Dh) ** -0.5)),
        }
    _A_in = _A_setup()

    def _B_setup():
        B, S, D, F = 1, 1, 576, 4608
        return {
            "x": _w((lambda *s: torch.randn(*s, dtype=torch.bfloat16) * 0.05)(B, S, D)),
            "w_gate": _w((lambda *s: torch.randn(*s, dtype=torch.bfloat16) * 0.05)(D, F)),
            "w_up": _w((lambda *s: torch.randn(*s, dtype=torch.bfloat16) * 0.05)(D, F)),
            "w_down": _w((lambda *s: torch.randn(*s, dtype=torch.bfloat16) * 0.05)(F, D)),
        }
    _B_in = _B_setup()

    return {
        "A_x": _A_in["x"],
        "A_k_cache": _A_in["k_cache"],
        "A_v_cache": _A_in["v_cache"],
        "A_wq": _A_in["wq"],
        "A_wo": _A_in["wo"],
        "B_x": _B_in["x"],
        "B_w_gate": _B_in["w_gate"],
        "B_w_up": _B_in["w_up"],
        "B_w_down": _B_in["w_down"],
    }

def reference(A_x, A_k_cache, A_v_cache, A_wq, A_wo, B_x, B_w_gate, B_w_up, B_w_down):
    def _A_ref(x, k_cache, v_cache, wq, wo):
        B, Sq, D = x.shape
        Hq, Dh = 32, 128
        Hkv, Sk = k_cache.shape[1], k_cache.shape[2]
        W = min(4096, max(256, Sk // 4))
        rep = Hq // Hkv
        q = (lambda x, *d: x.permute(*d))((x @ wq).reshape(B, Sq, Hq, Dh), 0, 2, 1, 3)
        k = (lambda x, n, axis: torch.repeat_interleave(x, n, dim=axis))(k_cache[:, :, Sk - W:, :], rep, axis=1)
        v = (lambda x, n, axis: torch.repeat_interleave(x, n, dim=axis))(v_cache[:, :, Sk - W:, :], rep, axis=1)
        scores = torch.einsum("bhqd,bhkd->bhqk", q, k) * (Dh ** -0.5)
        p = _softmax(scores, axis=-1)
        o = torch.einsum("bhqk,bhkd->bhqd", p, v)
        return (lambda x, *d: x.permute(*d))(o, 0, 2, 1, 3).reshape(B, Sq, Hq * Dh) @ wo

    def _B_ref(x, w_gate, w_up, w_down):
        g = _silu(x @ w_gate)
        u = x @ w_up
        return (g * u) @ w_down

    x = A_x
    xn = _layernorm(x, axis=-1)
    return x + _A_ref(xn, A_k_cache, A_v_cache, A_wq, A_wo) + _B_ref(xn, B_w_gate, B_w_up, B_w_down)
```

```asm
; @launch grid=(256,1,1) block=(512,1,1) lds=11264
.amdgcn_target "amdgcn-amd-amdhsa--gfx950"
.text
.globl parallel_sum__sliding_block_cached__swiglu_ffn__decode_kernel
.p2align 8
.type parallel_sum__sliding_block_cached__swiglu_ffn__decode_kernel,@function
parallel_sum__sliding_block_cached__swiglu_ffn__decode_kernel:
    s_load_dwordx16 s[4:19], s[0:1], 0
    s_load_dwordx8 s[20:27], s[0:1], 64
    s_cmp_ge_u32 s2, 256
    s_cbranch_scc1 L_end
    s_cmp_lt_u32 s2, 32
    s_cbranch_scc0 L_nopf
    s_getpc_b64 s[62:63]
L_pc:
    v_cmp_gt_u32 vcc, 128, v0
    s_cbranch_vccz L_nopf
    v_lshlrev_b32 v9, 7, v0
    v_min_u32 v9, L_last-L_pc, v9
    v_mov_b32 v13, s63
    v_add_co_u32 v12, vcc, s62, v9
    s_nop 1
    v_addc_co_u32 v13, vcc, 0, v13, vcc
    global_load_dword v63, v[12:13], off
L_nopf:
    v_and_b32 v1, 63, v0
    v_lshrrev_b32 v9, 6, v0
    s_and_b32 s29, s2, 7
    s_lshl_b32 s29, s29, 1
    s_bfe_u32 s31, s2, 0x10003
    s_add_u32 s29, s29, s31
    v_readfirstlane_b32 s28, v9
    s_lshr_b32 s30, s2, 4
    v_lshrrev_b32 v15, 3, v1
    v_and_b32 v18, 7, v1
    v_lshlrev_b32 v18, 4, v18
    v_lshl_add_u32 v17, v15, 13, v18
    s_lshr_b32 s31, s30, 2
    s_mul_i32 s50, s31, 1179648
    s_lshl_b32 s31, s29, 9
    s_add_u32 s50, s50, s31
    s_and_b32 s31, s30, 3
    s_lshl_b32 s31, s31, 7
    s_add_u32 s50, s50, s31
    v_lshlrev_b32 v19, 2, v1
    s_mov_b32 s35, 0x20000
    s_mov_b32 s39, s35
    s_mov_b32 s66, 0x10000
    s_movk_i32 s34, 1152
    s_mov_b32 s38, 0x480000
    s_cmp_eq_u32 s28, 0
    s_cbranch_scc0 L_oth
    s_waitcnt lgkmcnt(0)
    s_mov_b64 s[32:33], s[4:5]
    s_mov_b64 s[36:37], s[10:11]
    buffer_load_dword v56, v19, s[32:35], 0 offen offset:0
    buffer_load_dword v57, v19, s[32:35], 0 offen offset:256
    buffer_load_dword v58, v19, s[32:35], 0 offen offset:512
    buffer_load_dword v59, v19, s[32:35], 0 offen offset:768
    buffer_load_dword v60, v19, s[32:35], 0 offen offset:1024
    buffer_load_dwordx4 v[64:67], v17, s[36:39], s50 offen nt
    s_add_u32 s50, s50, s66
    buffer_load_dwordx4 v[68:71], v17, s[36:39], s50 offen nt
    s_add_u32 s50, s50, s66
    buffer_load_dwordx4 v[72:75], v17, s[36:39], s50 offen nt
    s_add_u32 s50, s50, s66
    buffer_load_dwordx4 v[76:79], v17, s[36:39], s50 offen nt
    s_add_u32 s50, s50, s66
    buffer_load_dwordx4 v[80:83], v17, s[36:39], s50 offen nt
    s_add_u32 s50, s50, s66
    buffer_load_dwordx4 v[84:87], v17, s[36:39], s50 offen nt
    s_add_u32 s50, s50, s66
    buffer_load_dwordx4 v[88:91], v17, s[36:39], s50 offen nt
    s_add_u32 s50, s50, s66
    buffer_load_dwordx4 v[92:95], v17, s[36:39], s50 offen nt
    s_add_u32 s50, s50, s66
    buffer_load_dwordx4 v[96:99], v17, s[36:39], s50 offen nt
    s_add_u32 s50, s50, s66
    buffer_load_dwordx4 v[100:103], v17, s[36:39], s50 offen nt
    s_add_u32 s50, s50, s66
    buffer_load_dwordx4 v[104:107], v17, s[36:39], s50 offen nt
    s_add_u32 s50, s50, s66
    buffer_load_dwordx4 v[108:111], v17, s[36:39], s50 offen nt
    s_add_u32 s50, s50, s66
    buffer_load_dwordx4 v[112:115], v17, s[36:39], s50 offen nt
    s_add_u32 s50, s50, s66
    buffer_load_dwordx4 v[116:119], v17, s[36:39], s50 offen nt
    s_add_u32 s50, s50, s66
    buffer_load_dwordx4 v[120:123], v17, s[36:39], s50 offen nt
    s_add_u32 s50, s50, s66
    buffer_load_dwordx4 v[124:127], v17, s[36:39], s50 offen nt
    s_add_u32 s50, s50, s66
    buffer_load_dwordx4 v[128:131], v17, s[36:39], s50 offen nt
    s_add_u32 s50, s50, s66
    buffer_load_dwordx4 v[132:135], v17, s[36:39], s50 offen nt
    v_mov_b32 v8, 0
    v_mov_b32 v16, v15
    v_bfe_u32 v3, v0, 4, 2
    v_mov_b32 v10, 0
    s_branch L_bar
L_oth:
    v_mov_b32 v8, 0
    v_mov_b32 v9, 0
    v_lshlrev_b32 v10, 3, v1
    ds_write_b64 v10, v[8:9]
    v_bfe_u32 v3, v0, 4, 2
    v_lshlrev_b32 v12, 4, v18
    v_and_b32 v10, 1, v15
    v_lshl_add_u32 v12, v10, 6, v12
    v_lshl_add_u32 v9, v3, 4, v12
    v_lshlrev_b32 v10, 4, v1
    s_sub_u32 s62, s28, 4
    s_lshl_b32 s63, s29, 24
    s_lshl_b32 s31, s30, 13
    s_add_u32 s63, s63, s31
    s_lshl_b32 s31, s62, 11
    s_add_u32 s63, s63, s31
    s_add_u32 s63, s63, 0xf00000
    s_mov_b32 s86, s63
    s_mov_b32 s66, 0x1e000
    s_mov_b32 s67, 0x20000
    s_add_u32 s31, s86, 0x2000
    s_movk_i32 s65, 0x2000
    s_and_b32 s63, s31, s66
    s_cselect_b32 s63, s67, 0
    s_add_u32 s87, s31, s63
    s_add_u32 s31, s87, s65
    s_and_b32 s63, s31, s66
    s_cselect_b32 s63, s67, 0
    s_add_u32 s88, s31, s63
    s_add_u32 s31, s88, s65
    s_and_b32 s63, s31, s66
    s_cselect_b32 s63, s67, 0
    s_add_u32 s89, s31, s63
    s_add_u32 s31, s89, s65
    s_and_b32 s63, s31, s66
    s_cselect_b32 s63, s67, 0
    s_add_u32 s90, s31, s63
    s_add_u32 s31, s90, s65
    s_and_b32 s63, s31, s66
    s_cselect_b32 s63, s67, 0
    s_add_u32 s91, s31, s63
    s_add_u32 s31, s91, s65
    s_and_b32 s63, s31, s66
    s_cselect_b32 s63, s67, 0
    s_add_u32 s92, s31, s63
    s_add_u32 s31, s92, s65
    s_and_b32 s63, s31, s66
    s_cselect_b32 s63, s67, 0
    s_add_u32 s93, s31, s63
    s_mov_b32 s34, 0x10000000
    s_mov_b32 s38, s34
    s_waitcnt lgkmcnt(0)
    s_mov_b64 s[32:33], s[6:7]
    s_mov_b64 s[36:37], s[8:9]
L_bar:
    s_barrier
    s_cmp_ge_u32 s28, 4
    s_cbranch_scc0 L_rest
    buffer_load_dwordx4 v[64:67], v9, s[32:35], s86 offen offset:0 nt
    buffer_load_dwordx4 v[68:71], v9, s[32:35], s86 offen offset:128 nt
    buffer_load_dwordx4 v[72:75], v9, s[32:35], s87 offen offset:0 nt
    buffer_load_dwordx4 v[76:79], v9, s[32:35], s87 offen offset:128 nt
    buffer_load_dwordx4 v[80:83], v9, s[32:35], s88 offen offset:0 nt
    buffer_load_dwordx4 v[84:87], v9, s[32:35], s88 offen offset:128 nt
    buffer_load_dwordx4 v[88:91], v9, s[32:35], s89 offen offset:0 nt
    buffer_load_dwordx4 v[92:95], v9, s[32:35], s89 offen offset:128 nt
L_rest:
    s_load_dword s48, s[26:27], 0x0
    s_mov_b32 s40, s26
    s_mov_b32 s41, s27
    s_mov_b32 s42, 0x40000000
    s_mov_b32 s43, 0x20000
    v_and_b32 v2, 15, v0
    v_and_b32 v12, 1, v0
    v_lshlrev_b32 v12, 4, v12
    s_mov_b32 s31, 0xffff
    v_lshlrev_b32 v12, v12, s31
    v_bfe_u32 v13, v0, 1, 2
    v_cmp_eq_u32 s[64:65], 0, v13
    v_cmp_eq_u32 s[66:67], 1, v13
    v_cmp_eq_u32 s[68:69], 2, v13
    v_cmp_eq_u32 s[70:71], 3, v13
    s_and_b32 s55, s30, 1
    s_lshl_b32 s54, s29, 3
    s_lshr_b32 s31, s30, 1
    s_add_u32 s54, s54, s31
    v_cndmask_b32 v4, 0, v12, s[64:65]
    v_cndmask_b32 v5, 0, v12, s[66:67]
    v_cndmask_b32 v6, 0, v12, s[68:69]
    v_cndmask_b32 v7, 0, v12, s[70:71]
    v_mov_b32 v11, 0xffffff00
    s_lshl_b32 s31, s55, 2
    s_add_u32 s31, s31, 32
    s_mulk_i32 s31, 1152
    s_mul_i32 s56, s54, s31
    s_movk_i32 s71, 4608
    s_lshl_b32 s31, s55, 7
    s_add_u32 s54, s54, s31
    s_lshr_b32 s64, s2, 3
    s_add_u32 s31, s64, 1
    s_lshr_b32 s31, s31, 3
    s_sub_u32 s78, s64, s31
    s_and_b32 s31, s64, 7
    s_cmp_eq_u32 s31, 6
    s_cselect_b32 s78, 31, s78
    s_add_u32 s31, s64, 1
    s_andn2_b32 s31, s31, 7
    s_and_b32 s65, s2, 7
    s_add_u32 s79, s31, s65
    s_cmp_lt_u32 s78, 27
    s_cselect_b32 s79, 63, s79
    s_mov_b32 s58, 0
    s_mov_b32 s59, -1
    s_mov_b32 s85, 0xffff0000
    s_mov_b32 s60, 0xff00ff00
    s_mov_b32 s61, 0xff00ff00
    s_mov_b32 s76, 0x0c0c0400
    s_mov_b32 s77, 0x04000c0c
    s_cmp_eq_u32 s28, 0
    s_cbranch_scc1 L_w0
    s_cmp_eq_u32 s28, 3
    s_cbranch_scc1 L_comm
    s_cmp_lt_u32 s28, 3
    s_cbranch_scc1 L_gu
    s_waitcnt vmcnt(7)
    buffer_load_dwordx4 v[96:99], v9, s[32:35], s90 offen offset:0 nt
    s_waitcnt vmcnt(7)
    buffer_load_dwordx4 v[100:103], v9, s[32:35], s90 offen offset:128 nt
    s_waitcnt vmcnt(6)
    buffer_load_dwordx4 v[104:107], v9, s[32:35], s91 offen offset:0 nt
    s_waitcnt vmcnt(5)
    buffer_load_dwordx4 v[108:111], v9, s[32:35], s91 offen offset:128 nt
    s_waitcnt vmcnt(5)
    buffer_load_dwordx4 v[112:115], v9, s[32:35], s92 offen offset:0 nt
    s_waitcnt vmcnt(5)
    buffer_load_dwordx4 v[116:119], v9, s[32:35], s92 offen offset:128 nt
    s_waitcnt vmcnt(5)
    buffer_load_dwordx4 v[120:123], v9, s[32:35], s93 offen offset:0 nt
    s_waitcnt vmcnt(5)
    buffer_load_dwordx4 v[124:127], v9, s[32:35], s93 offen offset:128 nt
    v_mov_b32 v12, 1
    s_mov_b64 exec, 1
    ds_add_u32 v8, v12 offset:28
    s_mov_b64 exec, -1
    s_waitcnt vmcnt(5)
    buffer_load_dwordx4 v[128:131], v10, s[36:39], s86 offen offset:0 nt
    s_waitcnt vmcnt(5)
    buffer_load_dwordx4 v[132:135], v10, s[36:39], s86 offen offset:1024 nt
    s_waitcnt vmcnt(5)
    buffer_load_dwordx4 v[136:139], v10, s[36:39], s87 offen offset:0 nt
    s_waitcnt vmcnt(5)
    buffer_load_dwordx4 v[140:143], v10, s[36:39], s87 offen offset:1024 nt
    s_waitcnt vmcnt(5)
    buffer_load_dwordx4 v[144:147], v10, s[36:39], s88 offen offset:0 nt
    s_waitcnt vmcnt(5)
    buffer_load_dwordx4 v[148:151], v10, s[36:39], s88 offen offset:1024 nt
    s_waitcnt vmcnt(5)
    buffer_load_dwordx4 v[152:155], v10, s[36:39], s89 offen offset:0 nt
    s_waitcnt vmcnt(5)
    buffer_load_dwordx4 v[156:159], v10, s[36:39], s89 offen offset:1024 nt
    s_waitcnt vmcnt(5)
    buffer_load_dwordx4 v[160:163], v10, s[36:39], s90 offen offset:0 nt
    s_waitcnt vmcnt(5)
    buffer_load_dwordx4 v[164:167], v10, s[36:39], s90 offen offset:1024 nt
    s_waitcnt vmcnt(5)
    buffer_load_dwordx4 v[168:171], v10, s[36:39], s91 offen offset:0 nt
    s_waitcnt vmcnt(5)
    buffer_load_dwordx4 v[172:175], v10, s[36:39], s91 offen offset:1024 nt
    s_waitcnt vmcnt(5)
    buffer_load_dwordx4 v[176:179], v10, s[36:39], s92 offen offset:0 nt
    s_waitcnt vmcnt(5)
    buffer_load_dwordx4 v[180:183], v10, s[36:39], s92 offen offset:1024 nt
    s_waitcnt vmcnt(5)
    buffer_load_dwordx4 v[184:187], v10, s[36:39], s93 offen offset:0 nt
    s_waitcnt vmcnt(5)
    buffer_load_dwordx4 v[188:191], v10, s[36:39], s93 offen offset:1024 nt
    v_mov_b32 v12, 1
    s_mov_b64 exec, 1
    ds_add_u32 v8, v12 offset:16
    s_mov_b64 exec, -1
L_attc:
    v_and_b32 v9, 1, v1
    v_lshlrev_b32 v9, 8, v9
    v_bfe_u32 v12, v1, 1, 1
    v_lshl_add_u32 v9, v12, 6, v9
    v_lshl_add_u32 v9, v3, 4, v9
    v_add_u32 v9, 3072, v9
    v_lshrrev_b32 v12, 2, v2
    v_mov_b32 v13, 64
    v_cmp_eq_u32 s[64:65], 0, v12
    v_cmp_eq_u32 s[66:67], 1, v12
    v_cmp_eq_u32 s[68:69], 2, v12
    v_cmp_eq_u32 s[70:71], 3, v12
    s_lshl_b32 s31, s62, 9
    s_addk_i32 s31, 3584
    v_and_b32 v18, 3, v1
    v_lshlrev_b32 v18, 6, v18
    v_lshrrev_b32 v19, 2, v1
    v_lshl_add_u32 v18, v19, 2, v18
    v_add_u32 v18, s31, v18
    v_lshrrev_b32 v19, 3, v2
    v_lshlrev_b32 v19, 8, v19
    v_lshl_add_u32 v19, v3, 6, v19
    v_add_u32 v19, s31, v19
    v_cndmask_b32 v14, v13, v9, s[64:65]
    v_cndmask_b32 v15, v13, v9, s[66:67]
    v_cndmask_b32 v16, v13, v9, s[68:69]
    v_cndmask_b32 v17, v13, v9, s[70:71]
    s_mov_b32 s51, 0x200000
L_spin_1:
    ds_read_b32 v20, v8 offset:4
    s_waitcnt lgkmcnt(0)
    v_readfirstlane_b32 s31, v20
    s_cmp_ge_u32 s31, 1
    s_cbranch_scc1 L_go_2
    s_sleep 1
    s_sub_u32 s51, s51, 1
    s_cbranch_scc0 L_spin_1
L_go_2:
    ds_read_b128 v[192:195], v14 offset:0
    ds_read_b128 v[196:199], v14 offset:128
    ds_read_b128 v[200:203], v15 offset:0
    ds_read_b128 v[204:207], v15 offset:128
    ds_read_b128 v[208:211], v16 offset:0
    ds_read_b128 v[212:215], v16 offset:128
    ds_read_b128 v[216:219], v17 offset:0
    ds_read_b128 v[220:223], v17 offset:128
    s_add_u32 s48, s48, 8
    s_and_b32 s72, s48, 0xff
    s_bfe_u32 s73, s48, 0x80008
    s_bfe_u32 s74, s48, 0x80010
    s_lshr_b32 s75, s48, 24
    s_waitcnt vmcnt(28) lgkmcnt(6)
    v_mfma_f32_16x16x32_bf16 v[24:27], v[192:195], v[64:67], 0
    v_mfma_f32_16x16x32_bf16 v[24:27], v[196:199], v[68:71], v[24:27]
    v_mfma_f32_16x16x32_bf16 v[28:31], v[192:195], v[72:75], 0
    v_mfma_f32_16x16x32_bf16 v[28:31], v[196:199], v[76:79], v[28:31]
    s_waitcnt vmcnt(24) lgkmcnt(4)
    v_mfma_f32_16x16x32_bf16 v[24:27], v[200:203], v[80:83], v[24:27]
    v_mfma_f32_16x16x32_bf16 v[24:27], v[204:207], v[84:87], v[24:27]
    v_mfma_f32_16x16x32_bf16 v[28:31], v[200:203], v[88:91], v[28:31]
    v_mfma_f32_16x16x32_bf16 v[28:31], v[204:207], v[92:95], v[28:31]
    s_waitcnt vmcnt(20) lgkmcnt(2)
    v_mfma_f32_16x16x32_bf16 v[24:27], v[208:211], v[96:99], v[24:27]
    v_mfma_f32_16x16x32_bf16 v[24:27], v[212:215], v[100:103], v[24:27]
    v_mfma_f32_16x16x32_bf16 v[28:31], v[208:211], v[104:107], v[28:31]
    v_mfma_f32_16x16x32_bf16 v[28:31], v[212:215], v[108:111], v[28:31]
    s_waitcnt vmcnt(16) lgkmcnt(0)
    v_mfma_f32_16x16x32_bf16 v[24:27], v[216:219], v[112:115], v[24:27]
    v_mfma_f32_16x16x32_bf16 v[24:27], v[220:223], v[116:119], v[24:27]
    v_mfma_f32_16x16x32_bf16 v[28:31], v[216:219], v[120:123], v[28:31]
    v_mfma_f32_16x16x32_bf16 v[28:31], v[220:223], v[124:127], v[28:31]
    s_nop 7
    v_cndmask_b32 v32, v24, v30, s[60:61]
    v_cndmask_b32 v34, v28, v26, s[60:61]
    v_cndmask_b32 v33, v25, v31, s[60:61]
    v_cndmask_b32 v35, v29, v27, s[60:61]
    s_nop 1
    v_add_f32_dpp v32, v34, v32 row_ror:8 row_mask:0xf bank_mask:0xf
    v_add_f32_dpp v33, v35, v33 row_ror:8 row_mask:0xf bank_mask:0xf
    s_mov_b32 s31, 0x3db504f3
    v_cvt_pk_bf16_f32 v34, v32, v33
    v_lshlrev_b32 v32, 16, v34
    v_and_b32 v33, s85, v34
    v_mul_f32 v32, s31, v32
    v_mul_f32 v33, s31, v33
    v_cvt_pk_bf16_f32 v34, v32, v33
    v_lshlrev_b32 v32, 16, v34
    v_and_b32 v33, s85, v34
    v_mov_b32 v36, v32
    v_mov_b32 v38, v33
    s_nop 1
    v_max_f32_dpp v36, v36, v36 row_ror:8 row_mask:0xf bank_mask:0xf
    v_max_f32_dpp v38, v38, v38 row_ror:8 row_mask:0xf bank_mask:0xf
    s_nop 0
    v_max_f32_dpp v36, v36, v36 row_ror:4 row_mask:0xf bank_mask:0xf
    v_max_f32_dpp v38, v38, v38 row_ror:4 row_mask:0xf bank_mask:0xf
    s_nop 0
    v_max_f32_dpp v36, v36, v36 row_ror:2 row_mask:0xf bank_mask:0xf
    v_max_f32_dpp v38, v38, v38 row_ror:2 row_mask:0xf bank_mask:0xf
    s_nop 0
    v_max_f32_dpp v36, v36, v36 row_ror:1 row_mask:0xf bank_mask:0xf
    v_max_f32_dpp v38, v38, v38 row_ror:1 row_mask:0xf bank_mask:0xf
    v_mov_b32 v34, v36
    v_mov_b32 v35, v38
    s_nop 1
    v_permlane16_swap_b32 v36, v34
    v_permlane16_swap_b32 v38, v35
    v_max_f32 v36, v36, v34
    v_max_f32 v38, v38, v35
    v_mov_b32 v34, v36
    v_mov_b32 v35, v38
    s_nop 1
    v_permlane32_swap_b32 v36, v34
    v_permlane32_swap_b32 v38, v35
    v_max_f32 v36, v36, v34
    v_max_f32 v38, v38, v35
    s_mov_b32 s31, 0x3fb8aa3b
    v_sub_f32 v32, v32, v36
    v_sub_f32 v33, v33, v38
    v_mul_f32 v32, s31, v32
    v_mul_f32 v33, s31, v33
    v_exp_f32 v37, v32
    v_exp_f32 v39, v33
    v_mul_f32 v36, s31, v36
    v_mul_f32 v38, s31, v38
    v_cvt_pk_bf16_f32 v32, v37, v37
    v_cvt_pk_bf16_f32 v33, v39, v39
    ds_write_b32 v18, v32
    ds_write_b32 v18, v33 offset:256
    ds_read_b128 v[192:195], v19 offset:0
    ds_read_b128 v[196:199], v19 offset:16
    ds_read_b128 v[200:203], v19 offset:32
    ds_read_b128 v[204:207], v19 offset:48
    s_nop 1
    v_add_f32_dpp v37, v37, v37 row_ror:8 row_mask:0xf bank_mask:0xf
    v_add_f32_dpp v39, v39, v39 row_ror:8 row_mask:0xf bank_mask:0xf
    s_nop 0
    v_add_f32_dpp v37, v37, v37 row_ror:4 row_mask:0xf bank_mask:0xf
    v_add_f32_dpp v39, v39, v39 row_ror:4 row_mask:0xf bank_mask:0xf
    s_nop 0
    v_add_f32_dpp v37, v37, v37 row_ror:2 row_mask:0xf bank_mask:0xf
    v_add_f32_dpp v39, v39, v39 row_ror:2 row_mask:0xf bank_mask:0xf
    s_nop 0
    v_add_f32_dpp v37, v37, v37 row_ror:1 row_mask:0xf bank_mask:0xf
    v_add_f32_dpp v39, v39, v39 row_ror:1 row_mask:0xf bank_mask:0xf
    v_mov_b32 v34, v37
    v_mov_b32 v35, v39
    s_nop 1
    v_permlane16_swap_b32 v37, v34
    v_permlane16_swap_b32 v39, v35
    v_add_f32 v37, v37, v34
    v_add_f32 v39, v39, v35
    v_mov_b32 v34, v37
    v_mov_b32 v35, v39
    s_nop 1
    v_permlane32_swap_b32 v37, v34
    v_permlane32_swap_b32 v39, v35
    v_add_f32 v37, v37, v34
    v_add_f32 v39, v39, v35
    s_lshl_b32 s31, s62, 4
    v_mov_b32 v20, s31
    s_mov_b64 exec, 1
    ds_write_b128 v20, v[36:39] offset:5632
    s_mov_b64 exec, -1
    s_waitcnt lgkmcnt(1)
    v_and_b32 v56, v192, v4
    v_and_b32 v57, v192, v5
    v_and_b32 v58, v192, v6
    v_and_b32 v59, v192, v7
    v_and_b32 v60, v193, v4
    v_and_b32 v61, v193, v5
    v_and_b32 v62, v193, v6
    v_and_b32 v63, v193, v7
    s_waitcnt vmcnt(15)
    v_mfma_f32_16x16x32_bf16 v[24:27], v[56:59], v[128:131], 0
    v_and_b32 v56, v194, v4
    v_and_b32 v57, v194, v5
    v_and_b32 v58, v194, v6
    v_and_b32 v59, v194, v7
    s_waitcnt vmcnt(14)
    v_mfma_f32_16x16x32_bf16 v[24:27], v[60:63], v[132:135], v[24:27]
    v_and_b32 v60, v195, v4
    v_and_b32 v61, v195, v5
    v_and_b32 v62, v195, v6
    v_and_b32 v63, v195, v7
    s_waitcnt vmcnt(13)
    v_mfma_f32_16x16x32_bf16 v[24:27], v[56:59], v[136:139], v[24:27]
    v_and_b32 v56, v196, v4
    v_and_b32 v57, v196, v5
    v_and_b32 v58, v196, v6
    v_and_b32 v59, v196, v7
    s_waitcnt vmcnt(12)
    v_mfma_f32_16x16x32_bf16 v[24:27], v[60:63], v[140:143], v[24:27]
    v_and_b32 v60, v197, v4
    v_and_b32 v61, v197, v5
    v_and_b32 v62, v197, v6
    v_and_b32 v63, v197, v7
    s_waitcnt vmcnt(11)
    v_mfma_f32_16x16x32_bf16 v[24:27], v[56:59], v[144:147], v[24:27]
    v_and_b32 v56, v198, v4
    v_and_b32 v57, v198, v5
    v_and_b32 v58, v198, v6
    v_and_b32 v59, v198, v7
    s_waitcnt vmcnt(10)
    v_mfma_f32_16x16x32_bf16 v[24:27], v[60:63], v[148:151], v[24:27]
    v_and_b32 v60, v199, v4
    v_and_b32 v61, v199, v5
    v_and_b32 v62, v199, v6
    v_and_b32 v63, v199, v7
    s_waitcnt vmcnt(9)
    v_mfma_f32_16x16x32_bf16 v[24:27], v[56:59], v[152:155], v[24:27]
    v_and_b32 v56, v200, v4
    v_and_b32 v57, v200, v5
    v_and_b32 v58, v200, v6
    v_and_b32 v59, v200, v7
    s_waitcnt vmcnt(8)
    v_mfma_f32_16x16x32_bf16 v[24:27], v[60:63], v[156:159], v[24:27]
    v_and_b32 v60, v201, v4
    v_and_b32 v61, v201, v5
    v_and_b32 v62, v201, v6
    v_and_b32 v63, v201, v7
    s_waitcnt vmcnt(7)
    v_mfma_f32_16x16x32_bf16 v[24:27], v[56:59], v[160:163], v[24:27]
    v_and_b32 v56, v202, v4
    v_and_b32 v57, v202, v5
    v_and_b32 v58, v202, v6
    v_and_b32 v59, v202, v7
    s_waitcnt vmcnt(6)
    v_mfma_f32_16x16x32_bf16 v[24:27], v[60:63], v[164:167], v[24:27]
    v_and_b32 v60, v203, v4
    v_and_b32 v61, v203, v5
    v_and_b32 v62, v203, v6
    v_and_b32 v63, v203, v7
    s_waitcnt vmcnt(5)
    v_mfma_f32_16x16x32_bf16 v[24:27], v[56:59], v[168:171], v[24:27]
    v_and_b32 v56, v204, v4
    v_and_b32 v57, v204, v5
    v_and_b32 v58, v204, v6
    v_and_b32 v59, v204, v7
    s_waitcnt vmcnt(4)
    v_mfma_f32_16x16x32_bf16 v[24:27], v[60:63], v[172:175], v[24:27]
    v_and_b32 v60, v205, v4
    v_and_b32 v61, v205, v5
    v_and_b32 v62, v205, v6
    v_and_b32 v63, v205, v7
    s_waitcnt vmcnt(3)
    v_mfma_f32_16x16x32_bf16 v[24:27], v[56:59], v[176:179], v[24:27]
    v_and_b32 v56, v206, v4
    v_and_b32 v57, v206, v5
    v_and_b32 v58, v206, v6
    v_and_b32 v59, v206, v7
    s_waitcnt vmcnt(2)
    v_mfma_f32_16x16x32_bf16 v[24:27], v[60:63], v[180:183], v[24:27]
    v_and_b32 v60, v207, v4
    v_and_b32 v61, v207, v5
    v_and_b32 v62, v207, v6
    v_and_b32 v63, v207, v7
    s_waitcnt vmcnt(1)
    v_mfma_f32_16x16x32_bf16 v[24:27], v[56:59], v[184:187], v[24:27]
    s_nop 1
    s_waitcnt vmcnt(0)
    v_mfma_f32_16x16x32_bf16 v[24:27], v[60:63], v[188:191], v[24:27]
    s_lshl_b32 s31, s62, 10
    v_add_u32 v20, s31, v10
    s_nop 5
    ds_write_b128 v20, v[24:27] offset:6144
    v_mov_b32 v21, 1
    s_mov_b64 exec, 1
    ds_add_u32 v8, v21 offset:8
    s_mov_b64 exec, -1
    s_cmp_lt_u32 s79, 36
    s_cbranch_scc0 L_done
    s_mov_b64 exec, 0
    s_branch L_fred
L_frr:
    s_mov_b64 exec, -1
    s_mov_b64 exec, 0
    s_branch L_ftl
L_ftr:
    s_mov_b64 exec, -1
    s_mov_b32 s51, 0x200000
L_spin_3:
    ds_read_b32 v20, v8 offset:12
    s_waitcnt lgkmcnt(0)
    v_readfirstlane_b32 s31, v20
    s_cmp_ge_u32 s31, 1
    s_cbranch_scc1 L_go_4
    s_sleep 1
    s_sub_u32 s51, s51, 1
    s_cbranch_scc0 L_spin_3
L_go_4:
    s_branch L_final
L_w0:
    s_setprio 3
    s_lshr_b32 s31, s30, 2
    s_mulk_i32 s31, 576
    s_addk_i32 s31, 512
    v_lshl_add_u32 v16, v16, 2, s31
    v_lshlrev_b32 v19, 3, v1
    s_waitcnt vmcnt(18)
    v_lshlrev_b32 v20, 16, v56
    v_and_b32 v21, s85, v56
    v_lshlrev_b32 v22, 16, v57
    v_and_b32 v23, s85, v57
    v_lshlrev_b32 v24, 16, v58
    v_and_b32 v25, s85, v58
    v_lshlrev_b32 v26, 16, v59
    v_and_b32 v27, s85, v59
    v_lshlrev_b32 v28, 16, v60
    v_and_b32 v29, s85, v60
    v_add_f32 v30, v20, v21
    v_add_f32 v31, v22, v23
    v_add_f32 v32, v24, v25
    v_add_f32 v33, v26, v27
    v_add_f32 v34, v28, v29
    v_add_f32 v30, v30, v31
    v_add_f32 v32, v32, v33
    v_add_f32 v30, v30, v34
    v_add_f32 v30, v30, v32
    s_nop 1
    v_add_f32_dpp v30, v30, v30 row_ror:8 row_mask:0xf bank_mask:0xf
    s_nop 1
    v_add_f32_dpp v30, v30, v30 row_ror:4 row_mask:0xf bank_mask:0xf
    s_nop 1
    v_add_f32_dpp v30, v30, v30 row_ror:2 row_mask:0xf bank_mask:0xf
    s_nop 1
    v_add_f32_dpp v30, v30, v30 row_ror:1 row_mask:0xf bank_mask:0xf
    v_mov_b32 v31, v30
    s_nop 1
    v_permlane16_swap_b32 v30, v31
    v_add_f32 v30, v30, v31
    v_mov_b32 v31, v30
    s_nop 1
    v_permlane32_swap_b32 v30, v31
    v_add_f32 v30, v30, v31
    v_mul_f32 v30, 0x3AE38E39, v30
    v_sub_f32 v32, v20, v30
    v_sub_f32 v33, v21, v30
    v_sub_f32 v34, v22, v30
    v_sub_f32 v35, v23, v30
    v_sub_f32 v36, v24, v30
    v_sub_f32 v37, v25, v30
    v_sub_f32 v38, v26, v30
    v_sub_f32 v39, v27, v30
    v_sub_f32 v40, v28, v30
    v_sub_f32 v41, v29, v30
    v_cndmask_b32 v40, v40, v8, s[58:59]
    v_cndmask_b32 v41, v41, v8, s[58:59]
    v_mul_f32 v31, v32, v32
    v_mul_f32 v42, v33, v33
    v_fmac_f32 v31, v34, v34
    v_fmac_f32 v42, v35, v35
    v_fmac_f32 v31, v36, v36
    v_fmac_f32 v42, v37, v37
    v_fmac_f32 v31, v38, v38
    v_fmac_f32 v42, v39, v39
    v_fmac_f32 v31, v40, v40
    v_fmac_f32 v42, v41, v41
    v_add_f32 v31, v31, v42
    s_nop 1
    v_add_f32_dpp v31, v31, v31 row_ror:8 row_mask:0xf bank_mask:0xf
    s_nop 1
    v_add_f32_dpp v31, v31, v31 row_ror:4 row_mask:0xf bank_mask:0xf
    s_nop 1
    v_add_f32_dpp v31, v31, v31 row_ror:2 row_mask:0xf bank_mask:0xf
    s_nop 1
    v_add_f32_dpp v31, v31, v31 row_ror:1 row_mask:0xf bank_mask:0xf
    v_mov_b32 v42, v31
    s_nop 1
    v_permlane16_swap_b32 v31, v42
    v_add_f32 v31, v31, v42
    v_mov_b32 v42, v31
    s_nop 1
    v_permlane32_swap_b32 v31, v42
    v_add_f32 v31, v31, v42
    v_mul_f32 v31, 0x3AE38E39, v31
    v_cvt_pk_bf16_f32 v30, v30, v30
    v_and_b32 v30, s85, v30
    v_cvt_pk_bf16_f32 v31, v31, v31
    v_and_b32 v31, s85, v31
    v_add_f32 v31, 0x3727C5AC, v31
    v_cvt_pk_bf16_f32 v31, v31, v31
    v_and_b32 v31, s85, v31
    v_sqrt_f32 v31, v31
    s_nop 0
    v_cvt_pk_bf16_f32 v31, v31, v31
    v_and_b32 v31, s85, v31
    v_rcp_f32 v42, v31
    v_sub_f32 v32, v20, v30
    v_sub_f32 v33, v21, v30
    v_sub_f32 v34, v22, v30
    v_sub_f32 v35, v23, v30
    v_sub_f32 v36, v24, v30
    v_sub_f32 v37, v25, v30
    v_sub_f32 v38, v26, v30
    v_sub_f32 v39, v27, v30
    v_sub_f32 v40, v28, v30
    v_sub_f32 v41, v29, v30
    v_cvt_pk_bf16_f32 v32, v32, v32
    v_cvt_pk_bf16_f32 v33, v33, v33
    v_cvt_pk_bf16_f32 v34, v34, v34
    v_cvt_pk_bf16_f32 v35, v35, v35
    v_cvt_pk_bf16_f32 v36, v36, v36
    v_cvt_pk_bf16_f32 v37, v37, v37
    v_cvt_pk_bf16_f32 v38, v38, v38
    v_cvt_pk_bf16_f32 v39, v39, v39
    v_cvt_pk_bf16_f32 v40, v40, v40
    v_cvt_pk_bf16_f32 v41, v41, v41
    v_and_b32 v32, s85, v32
    v_and_b32 v33, s85, v33
    v_and_b32 v34, s85, v34
    v_and_b32 v35, s85, v35
    v_and_b32 v36, s85, v36
    v_and_b32 v37, s85, v37
    v_and_b32 v38, s85, v38
    v_and_b32 v39, s85, v39
    v_and_b32 v40, s85, v40
    v_and_b32 v41, s85, v41
    v_mul_f32 v20, v32, v42
    v_mul_f32 v21, v33, v42
    v_mul_f32 v22, v34, v42
    v_mul_f32 v23, v35, v42
    v_mul_f32 v24, v36, v42
    v_mul_f32 v25, v37, v42
    v_mul_f32 v26, v38, v42
    v_mul_f32 v27, v39, v42
    v_mul_f32 v28, v40, v42
    v_mul_f32 v29, v41, v42
    v_fma_f32 v32, -v20, v31, v32
    v_fma_f32 v33, -v21, v31, v33
    v_fma_f32 v34, -v22, v31, v34
    v_fma_f32 v35, -v23, v31, v35
    v_fma_f32 v36, -v24, v31, v36
    v_fma_f32 v37, -v25, v31, v37
    v_fma_f32 v38, -v26, v31, v38
    v_fma_f32 v39, -v27, v31, v39
    v_fma_f32 v40, -v28, v31, v40
    v_fma_f32 v41, -v29, v31, v41
    v_fmac_f32 v20, v32, v42
    v_fmac_f32 v21, v33, v42
    v_fmac_f32 v22, v34, v42
    v_fmac_f32 v23, v35, v42
    v_fmac_f32 v24, v36, v42
    v_fmac_f32 v25, v37, v42
    v_fmac_f32 v26, v38, v42
    v_fmac_f32 v27, v39, v42
    v_fmac_f32 v28, v40, v42
    v_fmac_f32 v29, v41, v42
    v_cvt_pk_bf16_f32 v20, v20, v20
    v_cvt_pk_bf16_f32 v21, v21, v21
    v_cvt_pk_bf16_f32 v22, v22, v22
    v_cvt_pk_bf16_f32 v23, v23, v23
    v_cvt_pk_bf16_f32 v24, v24, v24
    v_cvt_pk_bf16_f32 v25, v25, v25
    v_cvt_pk_bf16_f32 v26, v26, v26
    v_cvt_pk_bf16_f32 v27, v27, v27
    v_cvt_pk_bf16_f32 v28, v28, v28
    v_cvt_pk_bf16_f32 v29, v29, v29
    ds_write_b64 v19, v[20:21] offset:512
    ds_write_b64 v19, v[22:23] offset:1024
    ds_write_b64 v19, v[24:25] offset:1536
    ds_write_b64 v19, v[26:27] offset:2048
    ds_write_b64 v19, v[28:29] offset:2560
    v_mov_b32 v30, 1
    ds_write_b32 v8, v30 offset:0
    ds_read2_b32 v[32:33], v16 offset0:0 offset1:8
    ds_read2_b32 v[34:35], v16 offset0:16 offset1:24
    ds_read2_b32 v[36:37], v16 offset0:32 offset1:40
    ds_read2_b32 v[38:39], v16 offset0:48 offset1:56
    ds_read2_b32 v[40:41], v16 offset0:64 offset1:72
    ds_read2_b32 v[42:43], v16 offset0:80 offset1:88
    ds_read2_b32 v[44:45], v16 offset0:96 offset1:104
    ds_read2_b32 v[46:47], v16 offset0:112 offset1:120
    ds_read2_b32 v[48:49], v16 offset0:128 offset1:136
    s_lshl_b32 s31, s29, 4
    s_add_u32 s31, s31, s30
    s_lshl_b32 s31, s31, 8
    s_add_u32 s62, s31, 4096
    v_lshlrev_b32 v9, 5, v2
    v_lshl_add_u32 v9, v3, 4, v9
    s_waitcnt lgkmcnt(0)
    s_add_u32 s48, s48, 8
    s_and_b32 s72, s48, 0xff
    s_bfe_u32 s73, s48, 0x80008
    s_bfe_u32 s74, s48, 0x80010
    s_lshr_b32 s75, s48, 24
    v_and_b32 v56, v32, v4
    v_and_b32 v57, v32, v5
    v_and_b32 v58, v32, v6
    v_and_b32 v59, v32, v7
    v_and_b32 v60, v33, v4
    v_and_b32 v61, v33, v5
    v_and_b32 v62, v33, v6
    v_and_b32 v63, v33, v7
    s_waitcnt vmcnt(17)
    v_mfma_f32_16x16x32_bf16 v[52:55], v[56:59], v[64:67], 0
    v_and_b32 v56, v34, v4
    v_and_b32 v57, v34, v5
    v_and_b32 v58, v34, v6
    v_and_b32 v59, v34, v7
    s_waitcnt vmcnt(16)
    v_mfma_f32_16x16x32_bf16 v[52:55], v[60:63], v[68:71], v[52:55]
    v_and_b32 v60, v35, v4
    v_and_b32 v61, v35, v5
    v_and_b32 v62, v35, v6
    v_and_b32 v63, v35, v7
    s_waitcnt vmcnt(15)
    v_mfma_f32_16x16x32_bf16 v[52:55], v[56:59], v[72:75], v[52:55]
    v_and_b32 v56, v36, v4
    v_and_b32 v57, v36, v5
    v_and_b32 v58, v36, v6
    v_and_b32 v59, v36, v7
    s_waitcnt vmcnt(14)
    v_mfma_f32_16x16x32_bf16 v[52:55], v[60:63], v[76:79], v[52:55]
    v_and_b32 v60, v37, v4
    v_and_b32 v61, v37, v5
    v_and_b32 v62, v37, v6
    v_and_b32 v63, v37, v7
    s_waitcnt vmcnt(13)
    v_mfma_f32_16x16x32_bf16 v[52:55], v[56:59], v[80:83], v[52:55]
    v_and_b32 v56, v38, v4
    v_and_b32 v57, v38, v5
    v_and_b32 v58, v38, v6
    v_and_b32 v59, v38, v7
    s_waitcnt vmcnt(12)
    v_mfma_f32_16x16x32_bf16 v[52:55], v[60:63], v[84:87], v[52:55]
    v_and_b32 v60, v39, v4
    v_and_b32 v61, v39, v5
    v_and_b32 v62, v39, v6
    v_and_b32 v63, v39, v7
    s_waitcnt vmcnt(11)
    v_mfma_f32_16x16x32_bf16 v[52:55], v[56:59], v[88:91], v[52:55]
    v_and_b32 v56, v40, v4
    v_and_b32 v57, v40, v5
    v_and_b32 v58, v40, v6
    v_and_b32 v59, v40, v7
    s_waitcnt vmcnt(10)
    v_mfma_f32_16x16x32_bf16 v[52:55], v[60:63], v[92:95], v[52:55]
    v_and_b32 v60, v41, v4
    v_and_b32 v61, v41, v5
    v_and_b32 v62, v41, v6
    v_and_b32 v63, v41, v7
    s_waitcnt vmcnt(9)
    v_mfma_f32_16x16x32_bf16 v[52:55], v[56:59], v[96:99], v[52:55]
    v_and_b32 v56, v42, v4
    v_and_b32 v57, v42, v5
    v_and_b32 v58, v42, v6
    v_and_b32 v59, v42, v7
    s_waitcnt vmcnt(8)
    v_mfma_f32_16x16x32_bf16 v[52:55], v[60:63], v[100:103], v[52:55]
    v_and_b32 v60, v43, v4
    v_and_b32 v61, v43, v5
    v_and_b32 v62, v43, v6
    v_and_b32 v63, v43, v7
    s_waitcnt vmcnt(7)
    v_mfma_f32_16x16x32_bf16 v[52:55], v[56:59], v[104:107], v[52:55]
    v_and_b32 v56, v44, v4
    v_and_b32 v57, v44, v5
    v_and_b32 v58, v44, v6
    v_and_b32 v59, v44, v7
    s_waitcnt vmcnt(6)
    v_mfma_f32_16x16x32_bf16 v[52:55], v[60:63], v[108:111], v[52:55]
    v_and_b32 v60, v45, v4
    v_and_b32 v61, v45, v5
    v_and_b32 v62, v45, v6
    v_and_b32 v63, v45, v7
    s_waitcnt vmcnt(5)
    v_mfma_f32_16x16x32_bf16 v[52:55], v[56:59], v[112:115], v[52:55]
    v_and_b32 v56, v46, v4
    v_and_b32 v57, v46, v5
    v_and_b32 v58, v46, v6
    v_and_b32 v59, v46, v7
    s_waitcnt vmcnt(4)
    v_mfma_f32_16x16x32_bf16 v[52:55], v[60:63], v[116:119], v[52:55]
    v_and_b32 v60, v47, v4
    v_and_b32 v61, v47, v5
    v_and_b32 v62, v47, v6
    v_and_b32 v63, v47, v7
    s_waitcnt vmcnt(3)
    v_mfma_f32_16x16x32_bf16 v[52:55], v[56:59], v[120:123], v[52:55]
    v_and_b32 v56, v48, v4
    v_and_b32 v57, v48, v5
    v_and_b32 v58, v48, v6
    v_and_b32 v59, v48, v7
    s_waitcnt vmcnt(2)
    v_mfma_f32_16x16x32_bf16 v[52:55], v[60:63], v[124:127], v[52:55]
    v_and_b32 v60, v49, v4
    v_and_b32 v61, v49, v5
    v_and_b32 v62, v49, v6
    v_and_b32 v63, v49, v7
    s_waitcnt vmcnt(1)
    v_mfma_f32_16x16x32_bf16 v[52:55], v[56:59], v[128:131], v[52:55]
    s_nop 1
    s_waitcnt vmcnt(0)
    v_mfma_f32_16x16x32_bf16 v[52:55], v[60:63], v[132:135], v[52:55]
    s_getreg_b32 s80, hwreg(HW_REG_XCC_ID, 0, 3)
    s_mov_b32 s63, s72
    s_andn2_b32 s72, s72, 7
    s_or_b32 s72, s72, s80
    s_nop 7
    v_mov_b32_dpp v20, v52 row_ror:8 row_mask:0xf bank_mask:0xf
    v_mov_b32_dpp v21, v53 row_ror:8 row_mask:0xf bank_mask:0xf
    v_mov_b32_dpp v22, v54 row_ror:8 row_mask:0xf bank_mask:0xf
    v_mov_b32_dpp v23, v55 row_ror:8 row_mask:0xf bank_mask:0xf
    s_nop 0
    v_permlane32_swap_b32 v20, v24
    v_permlane32_swap_b32 v21, v25
    v_permlane32_swap_b32 v22, v26
    v_permlane32_swap_b32 v23, v27
    v_add_f32 v20, v52, v24
    v_add_f32 v21, v53, v25
    v_add_f32 v22, v54, v26
    v_add_f32 v23, v55, v27
    v_and_or_b32 v20, v20, v11, s72
    v_and_or_b32 v21, v21, v11, s73
    v_and_or_b32 v22, v22, v11, s74
    v_and_or_b32 v23, v23, v11, s75
    s_mov_b64 exec, 0x00ff00ff
    buffer_store_dwordx4 v[20:23], v9, s[40:43], s62 offen sc1
    s_mov_b64 exec, -1
    s_mov_b32 s72, s63
    s_cmp_eq_u32 s55, 0
    s_cselect_b32 s44, s12, s20
    s_cselect_b32 s45, s13, s21
    s_mov_b32 s31, 0x480000
    s_cselect_b32 s46, s31, 0x510000
    s_mov_b32 s47, 0x20000
    v_mul_u32_u24 v17, 1152, v15
    v_add_u32 v17, v17, v18
    s_add_u32 s50, s56, 1024
    v_lshlrev_b32 v16, 2, v15
    s_mov_b64 exec, 0
    s_branch L_w0g
L_w0r:
    s_mov_b64 exec, -1
    s_mov_b32 s51, 0x200000
L_spin_5:
    ds_read_b32 v30, v8 offset:16
    s_waitcnt lgkmcnt(0)
    v_readfirstlane_b32 s31, v30
    s_cmp_ge_u32 s31, 4
    s_cbranch_scc1 L_go_6
    s_sleep 1
    s_sub_u32 s51, s51, 1
    s_cbranch_scc0 L_spin_5
L_go_6:
    buffer_load_dwordx4 v[64:67], v17, s[44:47], s50 offen nt
    s_addk_i32 s50, 9216
    buffer_load_dwordx4 v[68:71], v17, s[44:47], s50 offen nt
    s_addk_i32 s50, 9216
    buffer_load_dwordx4 v[72:75], v17, s[44:47], s50 offen nt
    s_addk_i32 s50, 9216
    buffer_load_dwordx4 v[76:79], v17, s[44:47], s50 offen nt
    s_addk_i32 s50, 9216
    buffer_load_dwordx4 v[80:83], v17, s[44:47], s50 offen nt
    s_lshl_b32 s50, s54, 6
    s_add_u32 s50, s50, 1048576
    v_lshrrev_b32 v9, 1, v2
    v_lshlrev_b32 v9, 14, v9
    v_and_b32 v10, 1, v2
    v_lshl_add_u32 v9, v10, 5, v9
    v_lshl_add_u32 v9, v3, 4, v9
    s_mov_b32 s51, 0x200000
L_spin_7:
    ds_read_b32 v30, v8 offset:20
    s_waitcnt lgkmcnt(0)
    v_readfirstlane_b32 s31, v30
    s_cmp_ge_u32 s31, 2
    s_cbranch_scc1 L_go_8
    s_sleep 1
    s_sub_u32 s51, s51, 1
    s_cbranch_scc0 L_spin_7
L_go_8:
    s_mov_b32 s51, 0x400000
L_spin_9:
    ds_read_b32 v30, v8 offset:12
    ds_read_b32 v32, v16 offset:5888
    ds_read_b32 v33, v16 offset:5920
    ds_read_b32 v34, v16 offset:5952
    ds_read_b32 v35, v16 offset:5984
    ds_read_b32 v36, v16 offset:6016
    s_waitcnt lgkmcnt(0)
    v_readfirstlane_b32 s31, v30
    s_cmp_lg_u32 s31, 0
    s_cbranch_scc1 L_go_10
    s_sub_u32 s51, s51, 1
    s_cbranch_scc0 L_spin_9
L_go_10:
    s_waitcnt lgkmcnt(0)
L_w0g:
    v_and_b32 v56, v32, v4
    v_and_b32 v57, v32, v5
    v_and_b32 v58, v32, v6
    v_and_b32 v59, v32, v7
    v_and_b32 v60, v33, v4
    v_and_b32 v61, v33, v5
    v_and_b32 v62, v33, v6
    v_and_b32 v63, v33, v7
    s_waitcnt vmcnt(4)
    v_mfma_f32_16x16x32_bf16 v[52:55], v[56:59], v[64:67], 0
    v_and_b32 v56, v34, v4
    v_and_b32 v57, v34, v5
    v_and_b32 v58, v34, v6
    v_and_b32 v59, v34, v7
    s_waitcnt vmcnt(3)
    v_mfma_f32_16x16x32_bf16 v[52:55], v[60:63], v[68:71], v[52:55]
    v_and_b32 v60, v35, v4
    v_and_b32 v61, v35, v5
    v_and_b32 v62, v35, v6
    v_and_b32 v63, v35, v7
    s_waitcnt vmcnt(2)
    v_mfma_f32_16x16x32_bf16 v[52:55], v[56:59], v[72:75], v[52:55]
    v_and_b32 v56, v36, v4
    v_and_b32 v57, v36, v5
    v_and_b32 v58, v36, v6
    v_and_b32 v59, v36, v7
    s_waitcnt vmcnt(1)
    v_mfma_f32_16x16x32_bf16 v[52:55], v[60:63], v[76:79], v[52:55]
    s_nop 1
    s_waitcnt vmcnt(0)
    v_mfma_f32_16x16x32_bf16 v[52:55], v[56:59], v[80:83], v[52:55]
    s_nop 7
    v_mov_b32_dpp v40, v52 row_ror:8 row_mask:0xf bank_mask:0xf
    v_mov_b32_dpp v41, v53 row_ror:8 row_mask:0xf bank_mask:0xf
    v_mov_b32_dpp v42, v54 row_ror:8 row_mask:0xf bank_mask:0xf
    v_mov_b32_dpp v43, v55 row_ror:8 row_mask:0xf bank_mask:0xf
    s_nop 0
    v_permlane32_swap_b32 v40, v44
    v_permlane32_swap_b32 v41, v45
    v_permlane32_swap_b32 v42, v46
    v_permlane32_swap_b32 v43, v47
    v_add_f32 v40, v52, v44
    v_add_f32 v41, v53, v45
    v_add_f32 v42, v54, v46
    v_add_f32 v43, v55, v47
    v_and_or_b32 v40, v40, v11, s72
    v_and_or_b32 v41, v41, v11, s73
    v_and_or_b32 v42, v42, v11, s74
    v_and_or_b32 v43, v43, v11, s75
    s_cbranch_execz L_w0r
    s_mov_b64 exec, 0x00ff00ff
    buffer_store_dwordx4 v[40:43], v9, s[40:43], s50 offen sc1
    s_mov_b64 exec, -1
    s_branch L_final
L_gu:
    s_cmp_eq_u32 s55, 0
    s_cselect_b32 s44, s12, s20
    s_cselect_b32 s45, s13, s21
    s_mov_b32 s31, 0x480000
    s_cselect_b32 s46, s31, 0x510000
    s_mov_b32 s47, 0x20000
    v_mul_u32_u24 v14, 1152, v3
    v_lshl_add_u32 v14, v2, 4, v14
    s_lshl_b32 s31, s28, 9
    s_add_u32 s66, s56, s31
    s_sub_u32 s66, s66, 512
    s_lshl_b32 s67, s54, 6
    s_lshl_b32 s31, s28, 18
    s_add_u32 s67, s67, s31
    s_add_u32 s67, s67, 262144
    s_add_u32 s68, s67, 131072
    v_lshrrev_b32 v61, 1, v2
    v_lshlrev_b32 v61, 14, v61
    v_and_b32 v60, 1, v2
    v_lshl_add_u32 v61, v60, 5, v61
    v_lshl_add_u32 v61, v3, 4, v61
    v_lshlrev_b32 v15, 2, v3
    v_add_u32 v15, 5888, v15
    v_lshlrev_b32 v13, 5, v2
    v_lshl_add_u32 v13, v3, 4, v13
    s_mov_b64 exec, 0
    s_branch L_gug
L_gur:
    s_mov_b64 exec, -1
    s_cmp_ge_u32 s78, 27
    s_cbranch_scc1 L_gu_none
    s_cmp_eq_u32 s28, 1
    s_cselect_b32 s32, s16, s18
    s_cselect_b32 s33, s17, s19
    s_mov_b32 s34, 0x510000
    s_mov_b32 s35, 0x20000
    s_mul_i32 s63, s78, 171
    s_lshr_b32 s63, s63, 9
    s_mul_i32 s31, s63, 3
    s_sub_u32 s62, s78, s31
    s_and_b32 s69, s2, 7
    s_sub_u32 s31, 3, s69
    s_and_b32 s31, s31, 7
    s_cmp_eq_u32 s69, 3
    s_cselect_b32 s31, 8, s31
    s_cselect_b32 s70, 7, 8
    s_add_u32 s31, s31, s63
    s_cmp_eq_u32 s28, 1
    s_cselect_b32 s70, 0, s70
    s_add_u32 s31, s31, s70
    s_sub_u32 s69, s31, 9
    s_cmp_ge_u32 s31, 9
    s_cselect_b32 s31, s69, s31
    s_sub_u32 s69, s31, 9
    s_cmp_ge_u32 s31, 9
    s_cselect_b32 s31, s69, s31
    s_mul_i32 s63, s62, 9
    s_add_u32 s63, s63, s31
    s_lshl_b32 s31, s31, 7
    s_mul_i32 s50, s62, 1769472
    s_add_u32 s50, s50, s31
    s_and_b32 s64, s2, 7
    s_mul_i32 s31, s64, 1152
    s_add_u32 s50, s50, s31
    v_lshrrev_b32 v10, 3, v1
    s_mov_b32 s31, 9216
    v_mul_lo_u32 v9, v10, s31
    v_and_b32 v12, 7, v1
    v_lshl_add_u32 v9, v12, 4, v9
    s_mulk_i32 s62, 768
    s_addk_i32 s62, 512
    v_mul_u32_u24 v10, 4, v10
    v_add_u32 v10, s62, v10
    s_mul_i32 s31, s64, 27
    s_add_u32 s31, s31, s63
    s_lshl_b32 s31, s31, 1
    s_add_u32 s31, s31, s28
    s_lshl_b32 s31, s31, 8
    s_add_u32 s65, s31, 73472
    s_mov_b32 s51, 0x200000
L_spin_11:
    ds_read_b32 v12, v8 offset:0
    s_waitcnt lgkmcnt(0)
    v_readfirstlane_b32 s31, v12
    s_cmp_ge_u32 s31, 1
    s_cbranch_scc1 L_go_12
    s_sleep 1
    s_sub_u32 s51, s51, 1
    s_cbranch_scc0 L_spin_11
L_go_12:
    ds_read2_b32 v[16:17], v10 offset0:0 offset1:8
    ds_read2_b32 v[18:19], v10 offset0:16 offset1:24
    ds_read2_b32 v[20:21], v10 offset0:32 offset1:40
    ds_read2_b32 v[22:23], v10 offset0:48 offset1:56
    ds_read2_b32 v[24:25], v10 offset0:64 offset1:72
    ds_read2_b32 v[26:27], v10 offset0:80 offset1:88
    ds_read2_b32 v[28:29], v10 offset0:96 offset1:104
    ds_read2_b32 v[30:31], v10 offset0:112 offset1:120
    ds_read2_b32 v[32:33], v10 offset0:128 offset1:136
    ds_read2_b32 v[34:35], v10 offset0:144 offset1:152
    ds_read2_b32 v[36:37], v10 offset0:160 offset1:168
    ds_read2_b32 v[38:39], v10 offset0:176 offset1:184
    s_add_u32 s48, s48, 8
    s_and_b32 s72, s48, 0xff
    s_bfe_u32 s73, s48, 0x80008
    s_bfe_u32 s74, s48, 0x80010
    s_lshr_b32 s75, s48, 24
    s_mov_b32 s70, 73728
    s_mov_b32 s51, 0x200000
L_spin_13:
    ds_read_b32 v12, v8 offset:16
    s_waitcnt lgkmcnt(0)
    v_readfirstlane_b32 s31, v12
    s_cmp_ge_u32 s31, 4
    s_cbranch_scc1 L_go_14
    s_sleep 1
    s_sub_u32 s51, s51, 1
    s_cbranch_scc0 L_spin_13
L_go_14:
    buffer_load_dwordx4 v[64:67], v9, s[32:35], s50 offen nt
    s_add_u32 s50, s50, s70
    buffer_load_dwordx4 v[68:71], v9, s[32:35], s50 offen nt
    s_add_u32 s50, s50, s70
    buffer_load_dwordx4 v[72:75], v9, s[32:35], s50 offen nt
    s_add_u32 s50, s50, s70
    buffer_load_dwordx4 v[76:79], v9, s[32:35], s50 offen nt
    s_add_u32 s50, s50, s70
    buffer_load_dwordx4 v[80:83], v9, s[32:35], s50 offen nt
    s_add_u32 s50, s50, s70
    buffer_load_dwordx4 v[84:87], v9, s[32:35], s50 offen nt
    s_add_u32 s50, s50, s70
    buffer_load_dwordx4 v[88:91], v9, s[32:35], s50 offen nt
    s_add_u32 s50, s50, s70
    buffer_load_dwordx4 v[92:95], v9, s[32:35], s50 offen nt
    s_add_u32 s50, s50, s70
    buffer_load_dwordx4 v[96:99], v9, s[32:35], s50 offen nt
    s_add_u32 s50, s50, s70
    buffer_load_dwordx4 v[100:103], v9, s[32:35], s50 offen nt
    s_add_u32 s50, s50, s70
    buffer_load_dwordx4 v[104:107], v9, s[32:35], s50 offen nt
    s_add_u32 s50, s50, s70
    buffer_load_dwordx4 v[108:111], v9, s[32:35], s50 offen nt
    s_add_u32 s50, s50, s70
    v_and_b32 v44, v16, v4
    v_and_b32 v45, v16, v5
    v_and_b32 v46, v16, v6
    v_and_b32 v47, v16, v7
    s_waitcnt vmcnt(11)
    s_nop 0
    v_mfma_f32_16x16x32_bf16 v[40:43], v[44:47], v[64:67], 0
    buffer_load_dwordx4 v[112:115], v9, s[32:35], s50 offen nt
    s_add_u32 s50, s50, s70
    v_and_b32 v48, v17, v4
    v_and_b32 v49, v17, v5
    v_and_b32 v50, v17, v6
    v_and_b32 v51, v17, v7
    s_waitcnt vmcnt(11)
    s_nop 0
    v_mfma_f32_16x16x32_bf16 v[40:43], v[48:51], v[68:71], v[40:43]
    buffer_load_dwordx4 v[116:119], v9, s[32:35], s50 offen nt
    s_add_u32 s50, s50, s70
    v_and_b32 v44, v18, v4
    v_and_b32 v45, v18, v5
    v_and_b32 v46, v18, v6
    v_and_b32 v47, v18, v7
    s_waitcnt vmcnt(11)
    s_nop 0
    v_mfma_f32_16x16x32_bf16 v[40:43], v[44:47], v[72:75], v[40:43]
    buffer_load_dwordx4 v[120:123], v9, s[32:35], s50 offen nt
    s_add_u32 s50, s50, s70
    v_and_b32 v48, v19, v4
    v_and_b32 v49, v19, v5
    v_and_b32 v50, v19, v6
    v_and_b32 v51, v19, v7
    s_waitcnt vmcnt(11)
    s_nop 0
    v_mfma_f32_16x16x32_bf16 v[40:43], v[48:51], v[76:79], v[40:43]
    buffer_load_dwordx4 v[124:127], v9, s[32:35], s50 offen nt
    s_add_u32 s50, s50, s70
    v_and_b32 v44, v20, v4
    v_and_b32 v45, v20, v5
    v_and_b32 v46, v20, v6
    v_and_b32 v47, v20, v7
    s_waitcnt vmcnt(11)
    s_nop 0
    v_mfma_f32_16x16x32_bf16 v[40:43], v[44:47], v[80:83], v[40:43]
    buffer_load_dwordx4 v[128:131], v9, s[32:35], s50 offen nt
    s_add_u32 s50, s50, s70
    v_and_b32 v48, v21, v4
    v_and_b32 v49, v21, v5
    v_and_b32 v50, v21, v6
    v_and_b32 v51, v21, v7
    s_waitcnt vmcnt(11)
    s_nop 0
    v_mfma_f32_16x16x32_bf16 v[40:43], v[48:51], v[84:87], v[40:43]
    buffer_load_dwordx4 v[132:135], v9, s[32:35], s50 offen nt
    s_add_u32 s50, s50, s70
    v_and_b32 v44, v22, v4
    v_and_b32 v45, v22, v5
    v_and_b32 v46, v22, v6
    v_and_b32 v47, v22, v7
    s_waitcnt vmcnt(11)
    s_nop 0
    v_mfma_f32_16x16x32_bf16 v[40:43], v[44:47], v[88:91], v[40:43]
    buffer_load_dwordx4 v[136:139], v9, s[32:35], s50 offen nt
    s_add_u32 s50, s50, s70
    v_and_b32 v48, v23, v4
    v_and_b32 v49, v23, v5
    v_and_b32 v50, v23, v6
    v_and_b32 v51, v23, v7
    s_waitcnt vmcnt(11)
    s_nop 0
    v_mfma_f32_16x16x32_bf16 v[40:43], v[48:51], v[92:95], v[40:43]
    buffer_load_dwordx4 v[140:143], v9, s[32:35], s50 offen nt
    s_add_u32 s50, s50, s70
    v_and_b32 v44, v24, v4
    v_and_b32 v45, v24, v5
    v_and_b32 v46, v24, v6
    v_and_b32 v47, v24, v7
    s_waitcnt vmcnt(11)
    s_nop 0
    v_mfma_f32_16x16x32_bf16 v[40:43], v[44:47], v[96:99], v[40:43]
    buffer_load_dwordx4 v[144:147], v9, s[32:35], s50 offen nt
    s_add_u32 s50, s50, s70
    v_and_b32 v48, v25, v4
    v_and_b32 v49, v25, v5
    v_and_b32 v50, v25, v6
    v_and_b32 v51, v25, v7
    s_waitcnt vmcnt(11)
    s_nop 0
    v_mfma_f32_16x16x32_bf16 v[40:43], v[48:51], v[100:103], v[40:43]
    buffer_load_dwordx4 v[148:151], v9, s[32:35], s50 offen nt
    s_add_u32 s50, s50, s70
    v_and_b32 v44, v26, v4
    v_and_b32 v45, v26, v5
    v_and_b32 v46, v26, v6
    v_and_b32 v47, v26, v7
    s_waitcnt vmcnt(11)
    s_nop 0
    v_mfma_f32_16x16x32_bf16 v[40:43], v[44:47], v[104:107], v[40:43]
    buffer_load_dwordx4 v[152:155], v9, s[32:35], s50 offen nt
    s_add_u32 s50, s50, s70
    v_and_b32 v48, v27, v4
    v_and_b32 v49, v27, v5
    v_and_b32 v50, v27, v6
    v_and_b32 v51, v27, v7
    s_waitcnt vmcnt(11)
    s_nop 0
    v_mfma_f32_16x16x32_bf16 v[40:43], v[48:51], v[108:111], v[40:43]
    buffer_load_dwordx4 v[156:159], v9, s[32:35], s50 offen nt
    v_and_b32 v44, v28, v4
    v_and_b32 v45, v28, v5
    v_and_b32 v46, v28, v6
    v_and_b32 v47, v28, v7
    s_waitcnt vmcnt(11)
    s_nop 0
    v_mfma_f32_16x16x32_bf16 v[40:43], v[44:47], v[112:115], v[40:43]
    buffer_load_dwordx4 v[160:163], v14, s[44:47], s66 offen offset:0 nt
    v_and_b32 v48, v29, v4
    v_and_b32 v49, v29, v5
    v_and_b32 v50, v29, v6
    v_and_b32 v51, v29, v7
    s_waitcnt vmcnt(11)
    s_nop 0
    v_mfma_f32_16x16x32_bf16 v[40:43], v[48:51], v[116:119], v[40:43]
    buffer_load_dwordx4 v[164:167], v14, s[44:47], s66 offen offset:256 nt
    s_add_u32 s66, s66, s71
    v_and_b32 v44, v30, v4
    v_and_b32 v45, v30, v5
    v_and_b32 v46, v30, v6
    v_and_b32 v47, v30, v7
    s_waitcnt vmcnt(11)
    s_nop 0
    v_mfma_f32_16x16x32_bf16 v[40:43], v[44:47], v[120:123], v[40:43]
    buffer_load_dwordx4 v[168:171], v14, s[44:47], s66 offen offset:0 nt
    v_and_b32 v48, v31, v4
    v_and_b32 v49, v31, v5
    v_and_b32 v50, v31, v6
    v_and_b32 v51, v31, v7
    s_waitcnt vmcnt(11)
    s_nop 0
    v_mfma_f32_16x16x32_bf16 v[40:43], v[48:51], v[124:127], v[40:43]
    buffer_load_dwordx4 v[172:175], v14, s[44:47], s66 offen offset:256 nt
    s_add_u32 s66, s66, s71
    v_and_b32 v44, v32, v4
    v_and_b32 v45, v32, v5
    v_and_b32 v46, v32, v6
    v_and_b32 v47, v32, v7
    s_waitcnt vmcnt(11)
    s_nop 0
    v_mfma_f32_16x16x32_bf16 v[40:43], v[44:47], v[128:131], v[40:43]
    buffer_load_dwordx4 v[176:179], v14, s[44:47], s66 offen offset:0 nt
    v_and_b32 v48, v33, v4
    v_and_b32 v49, v33, v5
    v_and_b32 v50, v33, v6
    v_and_b32 v51, v33, v7
    s_waitcnt vmcnt(11)
    s_nop 0
    v_mfma_f32_16x16x32_bf16 v[40:43], v[48:51], v[132:135], v[40:43]
    buffer_load_dwordx4 v[180:183], v14, s[44:47], s66 offen offset:256 nt
    s_add_u32 s66, s66, s71
    v_and_b32 v44, v34, v4
    v_and_b32 v45, v34, v5
    v_and_b32 v46, v34, v6
    v_and_b32 v47, v34, v7
    s_waitcnt vmcnt(11)
    s_nop 0
    v_mfma_f32_16x16x32_bf16 v[40:43], v[44:47], v[136:139], v[40:43]
    buffer_load_dwordx4 v[184:187], v14, s[44:47], s66 offen offset:0 nt
    v_and_b32 v48, v35, v4
    v_and_b32 v49, v35, v5
    v_and_b32 v50, v35, v6
    v_and_b32 v51, v35, v7
    s_waitcnt vmcnt(11)
    s_nop 0
    v_mfma_f32_16x16x32_bf16 v[40:43], v[48:51], v[140:143], v[40:43]
    buffer_load_dwordx4 v[188:191], v14, s[44:47], s66 offen offset:256 nt
    s_add_u32 s66, s66, s71
    v_and_b32 v44, v36, v4
    v_and_b32 v45, v36, v5
    v_and_b32 v46, v36, v6
    v_and_b32 v47, v36, v7
    s_waitcnt vmcnt(11)
    s_nop 0
    v_mfma_f32_16x16x32_bf16 v[40:43], v[44:47], v[144:147], v[40:43]
    buffer_load_dwordx4 v[192:195], v14, s[44:47], s66 offen offset:0 nt
    ds_read_b32 v12, v8 offset:24
    v_and_b32 v48, v37, v4
    v_and_b32 v49, v37, v5
    v_and_b32 v50, v37, v6
    v_and_b32 v51, v37, v7
    s_waitcnt vmcnt(11)
    s_nop 0
    v_mfma_f32_16x16x32_bf16 v[40:43], v[48:51], v[148:151], v[40:43]
    buffer_load_dwordx4 v[196:199], v14, s[44:47], s66 offen offset:256 nt
    s_add_u32 s66, s66, s71
    v_and_b32 v44, v38, v4
    v_and_b32 v45, v38, v5
    v_and_b32 v46, v38, v6
    v_and_b32 v47, v38, v7
    s_waitcnt vmcnt(11)
    s_nop 0
    v_mfma_f32_16x16x32_bf16 v[40:43], v[44:47], v[152:155], v[40:43]
    buffer_load_dwordx4 v[200:203], v14, s[44:47], s66 offen offset:0 nt
    s_waitcnt lgkmcnt(0)
    v_readfirstlane_b32 s81, v12
    v_and_b32 v48, v39, v4
    v_and_b32 v49, v39, v5
    v_and_b32 v50, v39, v6
    v_and_b32 v51, v39, v7
    s_waitcnt vmcnt(11)
    s_nop 0
    v_mfma_f32_16x16x32_bf16 v[40:43], v[48:51], v[156:159], v[40:43]
    s_nop 7
    v_mov_b32_dpp v52, v40 row_ror:8 row_mask:0xf bank_mask:0xf
    v_mov_b32_dpp v53, v41 row_ror:8 row_mask:0xf bank_mask:0xf
    v_mov_b32_dpp v54, v42 row_ror:8 row_mask:0xf bank_mask:0xf
    v_mov_b32_dpp v55, v43 row_ror:8 row_mask:0xf bank_mask:0xf
    s_nop 0
    v_permlane32_swap_b32 v52, v56
    v_permlane32_swap_b32 v53, v57
    v_permlane32_swap_b32 v54, v58
    v_permlane32_swap_b32 v55, v59
    v_add_f32 v52, v40, v56
    v_add_f32 v53, v41, v57
    v_add_f32 v54, v42, v58
    v_add_f32 v55, v43, v59
    v_and_or_b32 v52, v52, v11, s72
    v_and_or_b32 v53, v53, v11, s73
    v_and_or_b32 v54, v54, v11, s74
    v_and_or_b32 v55, v55, v11, s75
    s_mov_b64 exec, 0x00ff00ff
    s_cmp_eq_u32 s81, 1
    s_cbranch_scc1 L_st_15
    buffer_store_dwordx4 v[52:55], v13, s[40:43], s65 offen sc1
    s_branch L_sd_16
L_st_15:
    buffer_store_dwordx4 v[52:55], v13, s[40:43], s65 offen
L_sd_16:
    s_mov_b64 exec, -1
    v_mov_b32 v12, 1
    s_mov_b64 exec, 1
    ds_add_u32 v8, v12 offset:20
    s_mov_b64 exec, -1
    buffer_load_dwordx4 v[204:207], v14, s[44:47], s66 offen offset:256 nt
    s_add_u32 s66, s66, s71
    buffer_load_dwordx4 v[208:211], v14, s[44:47], s66 offen offset:0 nt
    buffer_load_dwordx4 v[212:215], v14, s[44:47], s66 offen offset:256 nt
    s_add_u32 s66, s66, s71
    buffer_load_dwordx4 v[216:219], v14, s[44:47], s66 offen offset:0 nt
    buffer_load_dwordx4 v[220:223], v14, s[44:47], s66 offen offset:256 nt
    s_add_u32 s66, s66, s71
    s_cmp_eq_u32 s55, 0
    s_cselect_b32 s66, 0x7fff0000, s66
    buffer_load_dwordx4 v[224:227], v14, s[44:47], s66 offen offset:0 nt
    buffer_load_dwordx4 v[228:231], v14, s[44:47], s66 offen offset:256 nt
    s_branch L_gu_last
L_gu_none:
    v_mov_b32 v12, 1
    s_mov_b64 exec, 1
    ds_add_u32 v8, v12 offset:20
    s_mov_b64 exec, -1
    s_mov_b32 s51, 0x200000
L_spin_17:
    ds_read_b32 v12, v8 offset:16
    s_waitcnt lgkmcnt(0)
    v_readfirstlane_b32 s31, v12
    s_cmp_ge_u32 s31, 4
    s_cbranch_scc1 L_go_18
    s_sleep 1
    s_sub_u32 s51, s51, 1
    s_cbranch_scc0 L_spin_17
L_go_18:
    s_add_u32 s48, s48, 8
    s_and_b32 s72, s48, 0xff
    s_bfe_u32 s73, s48, 0x80008
    s_bfe_u32 s74, s48, 0x80010
    s_lshr_b32 s75, s48, 24
    buffer_load_dwordx4 v[160:163], v14, s[44:47], s66 offen offset:0 nt
    buffer_load_dwordx4 v[164:167], v14, s[44:47], s66 offen offset:256 nt
    s_add_u32 s66, s66, s71
    buffer_load_dwordx4 v[168:171], v14, s[44:47], s66 offen offset:0 nt
    buffer_load_dwordx4 v[172:175], v14, s[44:47], s66 offen offset:256 nt
    s_add_u32 s66, s66, s71
    buffer_load_dwordx4 v[176:179], v14, s[44:47], s66 offen offset:0 nt
    buffer_load_dwordx4 v[180:183], v14, s[44:47], s66 offen offset:256 nt
    s_add_u32 s66, s66, s71
    buffer_load_dwordx4 v[184:187], v14, s[44:47], s66 offen offset:0 nt
    buffer_load_dwordx4 v[188:191], v14, s[44:47], s66 offen offset:256 nt
    s_add_u32 s66, s66, s71
    buffer_load_dwordx4 v[192:195], v14, s[44:47], s66 offen offset:0 nt
    buffer_load_dwordx4 v[196:199], v14, s[44:47], s66 offen offset:256 nt
    s_add_u32 s66, s66, s71
    buffer_load_dwordx4 v[200:203], v14, s[44:47], s66 offen offset:0 nt
    buffer_load_dwordx4 v[204:207], v14, s[44:47], s66 offen offset:256 nt
    s_add_u32 s66, s66, s71
    buffer_load_dwordx4 v[208:211], v14, s[44:47], s66 offen offset:0 nt
    buffer_load_dwordx4 v[212:215], v14, s[44:47], s66 offen offset:256 nt
    s_add_u32 s66, s66, s71
    buffer_load_dwordx4 v[216:219], v14, s[44:47], s66 offen offset:0 nt
    buffer_load_dwordx4 v[220:223], v14, s[44:47], s66 offen offset:256 nt
    s_add_u32 s66, s66, s71
    s_cmp_eq_u32 s55, 0
    s_cselect_b32 s66, 0x7fff0000, s66
    buffer_load_dwordx4 v[224:227], v14, s[44:47], s66 offen offset:0 nt
    buffer_load_dwordx4 v[228:231], v14, s[44:47], s66 offen offset:256 nt
L_gu_last:
    s_mov_b32 s51, 0x400000
L_spin_19:
    ds_read_b32 v12, v8 offset:12
    ds_read2_b32 v[16:17], v15 offset0:0 offset1:4
    ds_read2_b32 v[18:19], v15 offset0:8 offset1:12
    ds_read2_b32 v[20:21], v15 offset0:16 offset1:20
    ds_read2_b32 v[22:23], v15 offset0:24 offset1:28
    ds_read_b32 v24, v15 offset:128
    s_waitcnt lgkmcnt(0)
    v_readfirstlane_b32 s31, v12
    s_cmp_lg_u32 s31, 0
    s_cbranch_scc1 L_go_20
    s_sub_u32 s51, s51, 1
    s_cbranch_scc0 L_spin_19
L_go_20:
L_gug:
    v_and_b32 v44, v16, v4
    v_and_b32 v45, v16, v5
    v_and_b32 v46, v16, v6
    v_and_b32 v47, v16, v7
    v_and_b32 v48, v17, v4
    v_and_b32 v49, v17, v5
    v_and_b32 v50, v17, v6
    v_and_b32 v51, v17, v7
    s_waitcnt vmcnt(16)
    v_mfma_f32_16x16x32_bf16 v[32:35], v[44:47], v[160:163], 0
    v_mfma_f32_16x16x32_bf16 v[36:39], v[44:47], v[164:167], 0
    v_and_b32 v44, v18, v4
    v_and_b32 v45, v18, v5
    v_and_b32 v46, v18, v6
    v_and_b32 v47, v18, v7
    s_waitcnt vmcnt(14)
    v_mfma_f32_16x16x32_bf16 v[32:35], v[48:51], v[168:171], v[32:35]
    v_mfma_f32_16x16x32_bf16 v[36:39], v[48:51], v[172:175], v[36:39]
    v_and_b32 v48, v19, v4
    v_and_b32 v49, v19, v5
    v_and_b32 v50, v19, v6
    v_and_b32 v51, v19, v7
    s_waitcnt vmcnt(12)
    v_mfma_f32_16x16x32_bf16 v[32:35], v[44:47], v[176:179], v[32:35]
    v_mfma_f32_16x16x32_bf16 v[36:39], v[44:47], v[180:183], v[36:39]
    v_and_b32 v44, v20, v4
    v_and_b32 v45, v20, v5
    v_and_b32 v46, v20, v6
    v_and_b32 v47, v20, v7
    s_waitcnt vmcnt(10)
    v_mfma_f32_16x16x32_bf16 v[32:35], v[48:51], v[184:187], v[32:35]
    v_mfma_f32_16x16x32_bf16 v[36:39], v[48:51], v[188:191], v[36:39]
    v_and_b32 v48, v21, v4
    v_and_b32 v49, v21, v5
    v_and_b32 v50, v21, v6
    v_and_b32 v51, v21, v7
    s_waitcnt vmcnt(8)
    v_mfma_f32_16x16x32_bf16 v[32:35], v[44:47], v[192:195], v[32:35]
    v_mfma_f32_16x16x32_bf16 v[36:39], v[44:47], v[196:199], v[36:39]
    v_and_b32 v44, v22, v4
    v_and_b32 v45, v22, v5
    v_and_b32 v46, v22, v6
    v_and_b32 v47, v22, v7
    s_waitcnt vmcnt(6)
    v_mfma_f32_16x16x32_bf16 v[32:35], v[48:51], v[200:203], v[32:35]
    v_mfma_f32_16x16x32_bf16 v[36:39], v[48:51], v[204:207], v[36:39]
    v_and_b32 v48, v23, v4
    v_and_b32 v49, v23, v5
    v_and_b32 v50, v23, v6
    v_and_b32 v51, v23, v7
    s_waitcnt vmcnt(4)
    v_mfma_f32_16x16x32_bf16 v[32:35], v[44:47], v[208:211], v[32:35]
    v_mfma_f32_16x16x32_bf16 v[36:39], v[44:47], v[212:215], v[36:39]
    v_and_b32 v44, v24, v4
    v_and_b32 v45, v24, v5
    v_and_b32 v46, v24, v6
    v_and_b32 v47, v24, v7
    s_waitcnt vmcnt(2)
    v_mfma_f32_16x16x32_bf16 v[32:35], v[48:51], v[216:219], v[32:35]
    v_mfma_f32_16x16x32_bf16 v[36:39], v[48:51], v[220:223], v[36:39]
    s_nop 1
    s_waitcnt vmcnt(0)
    v_mfma_f32_16x16x32_bf16 v[32:35], v[44:47], v[224:227], v[32:35]
    v_mfma_f32_16x16x32_bf16 v[36:39], v[44:47], v[228:231], v[36:39]
    s_nop 6
    v_and_or_b32 v52, v32, v11, s72
    v_and_or_b32 v53, v33, v11, s73
    v_and_or_b32 v54, v34, v11, s74
    v_and_or_b32 v55, v35, v11, s75
    v_and_or_b32 v56, v36, v11, s72
    v_and_or_b32 v57, v37, v11, s73
    v_and_or_b32 v58, v38, v11, s74
    v_and_or_b32 v59, v39, v11, s75
    s_cbranch_execz L_gur
    s_mov_b64 exec, 0xffffffff
    buffer_store_dwordx4 v[52:55], v61, s[40:43], s67 offen sc1
    buffer_store_dwordx4 v[56:59], v61, s[40:43], s68 offen sc1
    s_mov_b64 exec, -1
    s_branch L_final
L_comm:
    s_setprio 3
    v_lshlrev_b32 v9, 4, v1
    s_lshl_b32 s88, s29, 12
    s_addk_i32 s88, 4096
    s_add_u32 s89, s88, 1024
    s_add_u32 s90, s88, 2048
    s_add_u32 s91, s88, 3072
    s_cmp_eq_u32 s55, 0
    s_cbranch_scc0 L_cB0
    v_lshrrev_b32 v12, 3, v1
    v_lshlrev_b32 v14, 10, v12
    v_and_b32 v13, 7, v1
    v_lshl_add_u32 v14, v13, 4, v14
    v_lshlrev_b32 v15, 3, v12
    v_lshlrev_b32 v13, 4, v1
    s_lshl_b32 s64, s29, 14
    s_lshl_b32 s31, s30, 6
    s_add_u32 s64, s64, s31
    s_add_u32 s64, s64, 196608
    s_add_u32 s65, s64, 8192
    s_lshl_b32 s66, s29, 8
    s_lshr_b32 s31, s30, 3
    s_lshl_b32 s31, s31, 7
    s_add_u32 s66, s66, s31
    s_add_u32 s66, s66, 69632
    s_add_u32 s67, s66, 64
    s_branch L_cB1
L_cB0:
    s_and_b32 s31, s54, 15
    s_mul_i32 s31, s31, 9
    v_bfe_u32 v12, v1, 1, 4
    v_add_u32 v12, s31, v12
    v_lshrrev_b32 v14, 4, v12
    v_lshlrev_b32 v14, 9, v14
    v_and_b32 v12, 15, v12
    v_lshl_add_u32 v14, v12, 4, v14
    v_lshrrev_b32 v12, 5, v1
    v_lshl_add_u32 v14, v12, 8, v14
    v_lshlrev_b32 v13, 3, v1
    v_mov_b32 v15, 0
    s_and_b32 s31, s2, 7
    s_mul_i32 s64, s31, 13824
    s_add_u32 s64, s64, 73728
    s_add_u32 s65, s64, 4608
    s_add_u32 s66, s64, 9216
    s_mov_b32 exec_lo, 0x3ffff
    s_mov_b32 exec_hi, 0x3ffff
    buffer_load_dword v52, v14, s[40:43], s64 offen sc0 sc1
    buffer_load_dword v53, v14, s[40:43], s65 offen sc0 sc1
    buffer_load_dword v54, v14, s[40:43], s66 offen sc0 sc1
    s_mov_b64 exec, -1
L_cB1:
    s_mov_b64 exec, 0
    s_branch L_mrg
L_mrr:
    s_mov_b64 exec, -1
    s_cmp_eq_u32 s55, 0
    s_mov_b64 exec, 0
    s_cbranch_scc1 L_postA
    s_branch L_postB
L_postr:
    s_mov_b64 exec, -1
    s_mov_b32 s51, 0x200000
L_spin_21:
    ds_read_b32 v12, v8 offset:28
    s_waitcnt lgkmcnt(0)
    v_readfirstlane_b32 s31, v12
    s_cmp_ge_u32 s31, 4
    s_cbranch_scc1 L_go_22
    s_sleep 1
    s_sub_u32 s51, s51, 1
    s_cbranch_scc0 L_spin_21
L_go_22:
    s_add_u32 s48, s48, 8
    s_and_b32 s72, s48, 0xff
    s_bfe_u32 s73, s48, 0x80008
    s_bfe_u32 s74, s48, 0x80010
    s_lshr_b32 s75, s48, 24
    s_getreg_b32 s80, hwreg(HW_REG_XCC_ID, 0, 3)
    s_xor_b32 s63, s29, 1
    s_lshl_b32 s63, s63, 12
    s_addk_i32 s63, 4096
    v_lshlrev_b32 v12, 8, v2
    s_andn2_b32 s62, s48, 7
    s_or_b32 s62, s62, s80
    s_mov_b32 s51, 0
    s_mov_b32 s51, 0
L_qg:
    buffer_load_dwordx4 v[16:19], v9, s[40:43], s88 offen sc0 sc1
    buffer_load_dwordx4 v[20:23], v9, s[40:43], s89 offen sc0 sc1
    buffer_load_dwordx4 v[24:27], v9, s[40:43], s90 offen sc0 sc1
    buffer_load_dwordx4 v[28:31], v9, s[40:43], s91 offen sc0 sc1
    v_mov_b32 v34, 0
    s_waitcnt vmcnt(3)
    v_perm_b32 v32, v17, v16, s76
    v_perm_b32 v33, v19, v18, s77
    v_or_b32 v32, v32, v33
    v_xor_b32 v32, s62, v32
    v_or_b32 v34, v34, v32
    s_waitcnt vmcnt(2)
    v_perm_b32 v32, v21, v20, s76
    v_perm_b32 v33, v23, v22, s77
    v_or_b32 v32, v32, v33
    v_xor_b32 v32, s62, v32
    v_or_b32 v34, v34, v32
    s_waitcnt vmcnt(1)
    v_perm_b32 v32, v25, v24, s76
    v_perm_b32 v33, v27, v26, s77
    v_or_b32 v32, v32, v33
    v_xor_b32 v32, s62, v32
    v_or_b32 v34, v34, v32
    s_waitcnt vmcnt(0)
    v_perm_b32 v32, v29, v28, s76
    v_perm_b32 v33, v31, v30, s77
    v_or_b32 v32, v32, v33
    v_xor_b32 v32, s62, v32
    v_or_b32 v34, v34, v32
    v_cmp_lt_u32 vcc, 7, v34
    s_cbranch_vccz L_qgd
    s_add_u32 s51, s51, 1
    s_cmp_lt_u32 s51, 0x40000
    s_cbranch_scc1 L_qg
L_qgd:
    v_mov_b32 v35, v34
    v_mov_b32 v40, v12
    v_and_b32 v16, v11, v16
    v_and_b32 v17, v11, v17
    v_and_b32 v18, v11, v18
    v_and_b32 v19, v11, v19
    v_and_b32 v20, v11, v20
    v_and_b32 v21, v11, v21
    v_and_b32 v22, v11, v22
    v_and_b32 v23, v11, v23
    v_and_b32 v24, v11, v24
    v_and_b32 v25, v11, v25
    v_and_b32 v26, v11, v26
    v_and_b32 v27, v11, v27
    v_and_b32 v28, v11, v28
    v_and_b32 v29, v11, v29
    v_and_b32 v30, v11, v30
    v_and_b32 v31, v11, v31
    v_add_f32 v16, v16, v20
    v_add_f32 v17, v17, v21
    v_add_f32 v18, v18, v22
    v_add_f32 v19, v19, v23
    v_add_f32 v24, v24, v28
    v_add_f32 v25, v25, v29
    v_add_f32 v26, v26, v30
    v_add_f32 v27, v27, v31
    v_add_f32 v16, v16, v24
    v_add_f32 v17, v17, v25
    v_add_f32 v18, v18, v26
    v_add_f32 v19, v19, v27
    v_cvt_pk_bf16_f32 v20, v16, v17
    v_cvt_pk_bf16_f32 v21, v18, v19
    v_lshlrev_b32 v12, 3, v1
    ds_write_b64 v12, v[20:21] offset:3072
    v_mov_b32 v22, 1
    ds_write_b32 v8, v22 offset:4
    s_mov_b32 s51, 0
L_sg:
    buffer_load_dwordx4 v[36:39], v40, s[40:43], s63 offen sc0 sc1
    v_mov_b32 v34, 0
    s_waitcnt vmcnt(0)
    v_perm_b32 v32, v37, v36, s76
    v_perm_b32 v33, v39, v38, s77
    v_or_b32 v32, v32, v33
    v_xor_b32 v32, s62, v32
    v_or_b32 v34, v34, v32
    v_cmp_lt_u32 vcc, 7, v34
    s_cbranch_vccz L_sgd
    s_add_u32 s51, s51, 1
    s_cmp_lt_u32 s51, 0x40000
    s_cbranch_scc1 L_sg
L_sgd:
    v_or_b32 v34, v34, v35
    v_cmp_ne_u32 vcc, 0, v34
    s_cmp_eq_u64 vcc, 0
    s_cselect_b32 s81, 1, 2
    v_mov_b32 v22, s81
    ds_write_b32 v8, v22 offset:24
    v_lshrrev_b32 v10, 5, v1
    v_lshlrev_b32 v46, 7, v10
    v_lshlrev_b32 v47, 9, v10
    v_lshlrev_b32 v10, 3, v10
    v_lshl_add_u32 v47, v2, 5, v47
    v_and_b32 v12, 1, v3
    v_lshl_add_u32 v47, v12, 4, v47
    s_lshl_b32 s31, s29, 4
    s_add_u32 s31, s31, s30
    s_lshl_b32 s31, s31, 10
    s_add_u32 s50, s31, 196608
    s_lshl_b32 s62, s29, 8
    s_lshl_b32 s31, s30, 3
    s_add_u32 s62, s62, s31
    s_add_u32 s62, s62, 69632
    s_mov_b32 s51, 0x200000
L_spin_23:
    ds_read_b32 v12, v8 offset:8
    s_waitcnt lgkmcnt(0)
    v_readfirstlane_b32 s31, v12
    s_cmp_ge_u32 s31, 4
    s_cbranch_scc1 L_go_24
    s_sleep 1
    s_sub_u32 s51, s51, 1
    s_cbranch_scc0 L_spin_23
L_go_24:
L_mrg:
    ds_read_b64 v[16:17], v10 offset:5632
    ds_read_b64 v[18:19], v10 offset:5648
    ds_read_b64 v[20:21], v10 offset:5664
    ds_read_b64 v[22:23], v10 offset:5680
    ds_read_b128 v[24:27], v9 offset:6144
    ds_read_b128 v[28:31], v9 offset:7168
    ds_read_b128 v[32:35], v9 offset:8192
    ds_read_b128 v[36:39], v9 offset:9216
    s_waitcnt lgkmcnt(4)
    v_max3_f32 v40, v16, v18, v20
    v_max_f32 v40, v40, v22
    v_sub_f32 v16, v16, v40
    v_sub_f32 v18, v18, v40
    v_sub_f32 v20, v20, v40
    v_sub_f32 v22, v22, v40
    v_exp_f32 v16, v16
    v_exp_f32 v18, v18
    v_exp_f32 v20, v20
    v_exp_f32 v22, v22
    s_nop 0
    v_mul_f32 v41, v16, v17
    v_fmac_f32 v41, v18, v19
    v_fmac_f32 v41, v20, v21
    v_fmac_f32 v41, v22, v23
    v_rcp_f32 v42, v41
    v_log_f32 v43, v41
    s_waitcnt lgkmcnt(0)
    v_mul_f32 v24, v24, v16
    v_mul_f32 v25, v25, v16
    v_mul_f32 v26, v26, v16
    v_mul_f32 v27, v27, v16
    v_fmac_f32 v24, v28, v18
    v_fmac_f32 v25, v29, v18
    v_fmac_f32 v26, v30, v18
    v_fmac_f32 v27, v31, v18
    v_fmac_f32 v24, v32, v20
    v_fmac_f32 v25, v33, v20
    v_fmac_f32 v26, v34, v20
    v_fmac_f32 v27, v35, v20
    v_fmac_f32 v24, v36, v22
    v_fmac_f32 v25, v37, v22
    v_fmac_f32 v26, v38, v22
    v_fmac_f32 v27, v39, v22
    v_add_f32 v44, v40, v43
    v_mov_b32 v45, s48
    v_mul_f32 v24, v24, v42
    v_mul_f32 v25, v25, v42
    v_mul_f32 v26, v26, v42
    v_mul_f32 v27, v27, v42
    v_and_or_b32 v48, v24, v11, s72
    v_and_or_b32 v49, v25, v11, s73
    v_and_or_b32 v50, v26, v11, s74
    v_and_or_b32 v51, v27, v11, s75
    s_cbranch_execz L_mrr
    s_mov_b64 exec, -1
    s_cmp_eq_u32 s81, 1
    s_cbranch_scc1 L_st_25
    buffer_store_dwordx4 v[48:51], v47, s[40:43], s50 offen sc1
    s_branch L_sd_26
L_st_25:
    buffer_store_dwordx4 v[48:51], v47, s[40:43], s50 offen
L_sd_26:
    s_mov_b32 exec_lo, 1
    s_mov_b32 exec_hi, 1
    s_cmp_eq_u32 s81, 1
    s_cbranch_scc1 L_st_27
    buffer_store_dwordx2 v[44:45], v46, s[40:43], s62 offen sc1
    s_branch L_sd_28
L_st_27:
    buffer_store_dwordx2 v[44:45], v46, s[40:43], s62 offen
L_sd_28:
    s_mov_b64 exec, -1
    s_cmp_eq_u32 s55, 0
    s_cbranch_scc0 L_commB
    s_mov_b32 s51, 0
L_gv_29:
    buffer_load_dwordx2 v[28:29], v15, s[40:43], s66 offen sc0 sc1
    buffer_load_dwordx2 v[30:31], v15, s[40:43], s67 offen sc0 sc1
    buffer_load_dwordx4 v[16:19], v14, s[40:43], s64 offen sc0 sc1
    buffer_load_dwordx4 v[20:23], v14, s[40:43], s65 offen sc0 sc1
    s_mov_b64 s[52:53], 0
    s_waitcnt vmcnt(3)
    v_cmp_ne_u32 vcc, s48, v29
    s_or_b64 s[52:53], s[52:53], vcc
    s_waitcnt vmcnt(2)
    v_cmp_ne_u32 vcc, s48, v31
    s_or_b64 s[52:53], s[52:53], vcc
    s_waitcnt vmcnt(1)
    v_perm_b32 v32, v17, v16, s76
    v_perm_b32 v33, v19, v18, s77
    v_or_b32 v32, v32, v33
    v_cmp_ne_u32 vcc, s48, v32
    s_or_b64 s[52:53], s[52:53], vcc
    s_waitcnt vmcnt(0)
    v_perm_b32 v32, v21, v20, s76
    v_perm_b32 v33, v23, v22, s77
    v_or_b32 v32, v32, v33
    v_cmp_ne_u32 vcc, s48, v32
    s_or_b64 s[52:53], s[52:53], vcc
    s_cbranch_scc0 L_gd_30
    s_add_u32 s51, s51, 1
    s_cmp_lt_u32 s51, 0x40000
    s_cbranch_scc1 L_gv_29
L_gd_30:
L_postA:
    v_max_f32 v32, v28, v30
    v_and_b32 v16, v11, v16
    v_and_b32 v17, v11, v17
    v_and_b32 v18, v11, v18
    v_and_b32 v19, v11, v19
    v_and_b32 v20, v11, v20
    v_and_b32 v21, v11, v21
    v_and_b32 v22, v11, v22
    v_and_b32 v23, v11, v23
    s_nop 1
    v_max_f32_dpp v32, v32, v32 row_ror:8 row_mask:0xf bank_mask:0xf
    v_mov_b32 v33, v32
    s_nop 1
    v_permlane16_swap_b32 v32, v33
    v_max_f32 v32, v32, v33
    v_mov_b32 v33, v32
    s_nop 1
    v_permlane32_swap_b32 v32, v33
    v_max_f32 v32, v32, v33
    v_sub_f32 v28, v28, v32
    v_sub_f32 v30, v30, v32
    v_exp_f32 v28, v28
    v_exp_f32 v30, v30
    s_nop 0
    v_mul_f32 v16, v16, v28
    v_mul_f32 v17, v17, v28
    v_mul_f32 v18, v18, v28
    v_mul_f32 v19, v19, v28
    v_add_f32 v24, v28, v30
    v_fmac_f32 v16, v20, v30
    v_fmac_f32 v17, v21, v30
    v_fmac_f32 v18, v22, v30
    v_fmac_f32 v19, v23, v30
    s_nop 1
    v_add_f32_dpp v24, v24, v24 row_ror:8 row_mask:0xf bank_mask:0xf
    v_add_f32_dpp v16, v16, v16 row_ror:8 row_mask:0xf bank_mask:0xf
    v_add_f32_dpp v17, v17, v17 row_ror:8 row_mask:0xf bank_mask:0xf
    v_add_f32_dpp v18, v18, v18 row_ror:8 row_mask:0xf bank_mask:0xf
    v_add_f32_dpp v19, v19, v19 row_ror:8 row_mask:0xf bank_mask:0xf
    v_mov_b32 v32, v24
    v_mov_b32 v33, v16
    v_mov_b32 v34, v17
    v_mov_b32 v35, v18
    v_mov_b32 v36, v19
    s_nop 0
    v_permlane16_swap_b32 v24, v32
    v_permlane16_swap_b32 v16, v33
    v_permlane16_swap_b32 v17, v34
    v_permlane16_swap_b32 v18, v35
    v_permlane16_swap_b32 v19, v36
    v_add_f32 v24, v24, v32
    v_add_f32 v16, v16, v33
    v_add_f32 v17, v17, v34
    v_add_f32 v18, v18, v35
    v_add_f32 v19, v19, v36
    v_mov_b32 v32, v24
    v_mov_b32 v33, v16
    v_mov_b32 v34, v17
    v_mov_b32 v35, v18
    v_mov_b32 v36, v19
    s_nop 0
    v_permlane32_swap_b32 v24, v32
    v_permlane32_swap_b32 v16, v33
    v_permlane32_swap_b32 v17, v34
    v_permlane32_swap_b32 v18, v35
    v_permlane32_swap_b32 v19, v36
    v_add_f32 v24, v24, v32
    v_add_f32 v16, v16, v33
    v_add_f32 v17, v17, v34
    v_add_f32 v18, v18, v35
    v_add_f32 v19, v19, v36
    v_rcp_f32 v24, v24
    s_mov_b64 s[60:61], 0xff
    v_mul_f32 v16, v16, v24
    v_mul_f32 v17, v17, v24
    v_mul_f32 v18, v18, v24
    v_mul_f32 v19, v19, v24
    v_cvt_pk_bf16_f32 v16, v16, v16
    v_cvt_pk_bf16_f32 v17, v17, v17
    v_cvt_pk_bf16_f32 v18, v18, v18
    v_cvt_pk_bf16_f32 v19, v19, v19
    v_cndmask_b32 v16, v8, v16, s[60:61]
    v_cndmask_b32 v17, v8, v17, s[60:61]
    v_cndmask_b32 v18, v8, v18, s[60:61]
    v_cndmask_b32 v19, v8, v19, s[60:61]
    s_cbranch_execz L_postr
    s_mov_b64 exec, 0x3ff
    ds_write_b128 v13, v[16:19] offset:5888
    s_branch L_commW
L_commB:
    s_mov_b32 s51, 0x200000
L_spin_31:
    ds_read_b32 v12, v8 offset:20
    s_waitcnt lgkmcnt(0)
    v_readfirstlane_b32 s31, v12
    s_cmp_ge_u32 s31, 2
    s_cbranch_scc1 L_go_32
    s_sleep 1
    s_sub_u32 s51, s51, 1
    s_cbranch_scc0 L_spin_31
L_go_32:
    s_mov_b32 exec_lo, 0x3ffff
    s_mov_b32 exec_hi, 0x3ffff
    s_mov_b32 s51, 0
L_gv_33:
    buffer_load_dwordx4 v[16:19], v14, s[40:43], s64 offen sc0 sc1
    buffer_load_dwordx4 v[20:23], v14, s[40:43], s65 offen sc0 sc1
    buffer_load_dwordx4 v[24:27], v14, s[40:43], s66 offen sc0 sc1
    s_mov_b64 s[52:53], 0
    s_waitcnt vmcnt(2)
    v_perm_b32 v32, v17, v16, s76
    v_perm_b32 v33, v19, v18, s77
    v_or_b32 v32, v32, v33
    v_cmp_ne_u32 vcc, s48, v32
    s_or_b64 s[52:53], s[52:53], vcc
    s_waitcnt vmcnt(1)
    v_perm_b32 v32, v21, v20, s76
    v_perm_b32 v33, v23, v22, s77
    v_or_b32 v32, v32, v33
    v_cmp_ne_u32 vcc, s48, v32
    s_or_b64 s[52:53], s[52:53], vcc
    s_waitcnt vmcnt(0)
    v_perm_b32 v32, v25, v24, s76
    v_perm_b32 v33, v27, v26, s77
    v_or_b32 v32, v32, v33
    v_cmp_ne_u32 vcc, s48, v32
    s_or_b64 s[52:53], s[52:53], vcc
    s_cbranch_scc0 L_gd_34
    s_add_u32 s51, s51, 1
    s_cmp_lt_u32 s51, 0x40000
    s_cbranch_scc1 L_gv_33
L_gd_34:
    s_mov_b64 exec, -1
L_postB:
    s_mov_b32 s68, 0xaaaaaaaa
    s_mov_b32 s69, 0xaaaaaaaa
    v_cndmask_b32 v16, v16, v18, s[68:69]
    v_cndmask_b32 v17, v17, v19, s[68:69]
    v_cndmask_b32 v20, v20, v22, s[68:69]
    v_cndmask_b32 v21, v21, v23, s[68:69]
    v_cndmask_b32 v24, v24, v26, s[68:69]
    v_cndmask_b32 v25, v25, v27, s[68:69]
    v_and_b32 v16, v11, v16
    v_and_b32 v17, v11, v17
    v_and_b32 v20, v11, v20
    v_and_b32 v21, v11, v21
    v_and_b32 v24, v11, v24
    v_and_b32 v25, v11, v25
    v_add_f32 v16, v16, v20
    v_add_f32 v17, v17, v21
    v_add_f32 v16, v16, v24
    v_add_f32 v17, v17, v25
    v_cvt_pk_bf16_f32 v16, v16, v17
    s_mov_b32 s31, 0xbfb8aa3b
    s_mov_b64 s[60:61], 0x3ffff
    v_permlane32_swap_b32 v16, v18
    v_and_b32 v17, s85, v16
    v_lshlrev_b32 v16, 16, v16
    v_mul_f32 v20, s31, v16
    v_mul_f32 v21, s31, v17
    v_exp_f32 v20, v20
    v_exp_f32 v21, v21
    v_and_b32 v19, s85, v18
    v_add_f32 v20, 1.0, v20
    v_add_f32 v21, 1.0, v21
    v_rcp_f32 v20, v20
    v_rcp_f32 v21, v21
    v_lshlrev_b32 v18, 16, v18
    v_mul_f32 v16, v16, v20
    v_mul_f32 v17, v17, v21
    v_cvt_pk_bf16_f32 v16, v16, v17
    v_and_b32 v17, s85, v16
    v_lshlrev_b32 v16, 16, v16
    v_mul_f32 v16, v16, v18
    v_mul_f32 v17, v17, v19
    v_cvt_pk_bf16_f32 v16, v16, v16
    v_cvt_pk_bf16_f32 v17, v17, v17
    v_cndmask_b32 v16, v8, v16, s[60:61]
    v_cndmask_b32 v17, v8, v17, s[60:61]
    s_cbranch_execz L_postr
    s_mov_b64 exec, 0xfffff
    ds_write_b64 v13, v[16:17] offset:5888
L_commW:
    s_mov_b64 exec, -1
    v_mov_b32 v22, 1
    ds_write_b32 v8, v22 offset:12
    s_branch L_final
L_final:
    s_mov_b32 s62, s79
    s_cmp_lt_u32 s62, 36
    s_cbranch_scc0 L_done
    s_setprio 3
    s_mov_b32 s32, s4
    s_mov_b32 s33, s5
    s_mov_b32 s34, 0x480
    s_mov_b32 s35, 0x20000
    v_lshlrev_b32 v9, 2, v1
    s_lshl_b32 s63, s62, 5
    buffer_load_dword v40, v9, s[32:35], s63 offen
    v_lshlrev_b32 v10, 6, v2
    v_lshl_add_u32 v10, v3, 4, v10
    s_lshl_b32 s64, s62, 14
    s_lshl_b32 s31, s28, 11
    s_add_u32 s64, s64, s31
    s_add_u32 s64, s64, 524288
    s_add_u32 s65, s64, 1024
    s_lshl_b32 s31, s28, 6
    v_lshlrev_b32 v13, 4, v3
    v_add_u32 v13, s31, v13
    v_lshlrev_b32 v14, 3, v1
    s_mov_b32 s32, s22
    s_mov_b32 s33, s23
    s_mov_b32 s34, 0x480
    s_mov_b32 s35, 0x20000
    s_mov_b32 s51, 0
L_gv_35:
    buffer_load_dwordx4 v[16:19], v10, s[40:43], s64 offen sc0 sc1
    buffer_load_dwordx4 v[20:23], v10, s[40:43], s65 offen sc0 sc1
    s_mov_b64 s[52:53], 0
    s_waitcnt vmcnt(1)
    v_perm_b32 v32, v17, v16, s76
    v_perm_b32 v33, v19, v18, s77
    v_or_b32 v32, v32, v33
    v_cmp_ne_u32 vcc, s48, v32
    s_or_b64 s[52:53], s[52:53], vcc
    s_waitcnt vmcnt(0)
    v_perm_b32 v32, v21, v20, s76
    v_perm_b32 v33, v23, v22, s77
    v_or_b32 v32, v32, v33
    v_cmp_ne_u32 vcc, s48, v32
    s_or_b64 s[52:53], s[52:53], vcc
    s_cbranch_scc0 L_gd_36
    s_add_u32 s51, s51, 1
    s_cmp_lt_u32 s51, 0x40000
    s_cbranch_scc1 L_gv_35
L_gd_36:
L_fred:
    v_and_b32 v16, v11, v16
    v_and_b32 v17, v11, v17
    v_and_b32 v18, v11, v18
    v_and_b32 v19, v11, v19
    v_and_b32 v20, v11, v20
    v_and_b32 v21, v11, v21
    v_and_b32 v22, v11, v22
    v_and_b32 v23, v11, v23
    v_add_f32 v16, v16, v20
    v_add_f32 v17, v17, v21
    v_add_f32 v18, v18, v22
    v_add_f32 v19, v19, v23
    s_nop 1
    v_add_f32_dpp v16, v16, v16 row_ror:8 row_mask:0xf bank_mask:0xf
    v_add_f32_dpp v17, v17, v17 row_ror:8 row_mask:0xf bank_mask:0xf
    v_add_f32_dpp v18, v18, v18 row_ror:8 row_mask:0xf bank_mask:0xf
    v_add_f32_dpp v19, v19, v19 row_ror:8 row_mask:0xf bank_mask:0xf
    v_add_f32_dpp v16, v16, v16 row_ror:4 row_mask:0xf bank_mask:0xf
    v_add_f32_dpp v17, v17, v17 row_ror:4 row_mask:0xf bank_mask:0xf
    v_add_f32_dpp v18, v18, v18 row_ror:4 row_mask:0xf bank_mask:0xf
    v_add_f32_dpp v19, v19, v19 row_ror:4 row_mask:0xf bank_mask:0xf
    v_add_f32_dpp v16, v16, v16 row_ror:2 row_mask:0xf bank_mask:0xf
    v_add_f32_dpp v17, v17, v17 row_ror:2 row_mask:0xf bank_mask:0xf
    v_add_f32_dpp v18, v18, v18 row_ror:2 row_mask:0xf bank_mask:0xf
    v_add_f32_dpp v19, v19, v19 row_ror:2 row_mask:0xf bank_mask:0xf
    v_add_f32_dpp v16, v16, v16 row_ror:1 row_mask:0xf bank_mask:0xf
    v_add_f32_dpp v17, v17, v17 row_ror:1 row_mask:0xf bank_mask:0xf
    v_add_f32_dpp v18, v18, v18 row_ror:1 row_mask:0xf bank_mask:0xf
    v_add_f32_dpp v19, v19, v19 row_ror:1 row_mask:0xf bank_mask:0xf
    s_cbranch_execz L_frr
    s_mov_b32 exec_lo, 0x10001
    s_mov_b32 exec_hi, 0x10001
    ds_write_b128 v13, v[16:19] offset:10240
    s_waitcnt lgkmcnt(0)
    s_barrier
    s_cmp_eq_u32 s28, 0
    s_cbranch_scc0 L_done
L_tail:
    s_mov_b64 exec, 0xff
L_ftl:
    ds_read_b64 v[16:17], v14 offset:10240
    ds_read_b64 v[18:19], v14 offset:10304
    ds_read_b64 v[20:21], v14 offset:10368
    ds_read_b64 v[22:23], v14 offset:10432
    ds_read_b64 v[24:25], v14 offset:10496
    ds_read_b64 v[26:27], v14 offset:10560
    ds_read_b64 v[28:29], v14 offset:10624
    ds_read_b64 v[30:31], v14 offset:10688
    v_lshlrev_b32 v41, 16, v40
    v_and_b32 v42, s85, v40
    s_waitcnt lgkmcnt(4)
    v_add_f32 v16, v16, v18
    v_add_f32 v20, v20, v22
    v_add_f32 v17, v17, v19
    v_add_f32 v21, v21, v23
    v_add_f32 v16, v16, v20
    v_add_f32 v17, v17, v21
    v_cvt_pk_bf16_f32 v16, v16, v17
    v_and_b32 v17, s85, v16
    v_lshlrev_b32 v16, 16, v16
    v_add_f32 v16, v16, v41
    v_add_f32 v17, v17, v42
    v_cvt_pk_bf16_f32 v16, v16, v17
    v_and_b32 v17, s85, v16
    v_lshlrev_b32 v16, 16, v16
    s_waitcnt lgkmcnt(0)
    v_add_f32 v24, v24, v26
    v_add_f32 v28, v28, v30
    v_add_f32 v25, v25, v27
    v_add_f32 v29, v29, v31
    v_add_f32 v24, v24, v28
    v_add_f32 v25, v25, v29
    v_cvt_pk_bf16_f32 v24, v24, v25
    v_and_b32 v25, s85, v24
    v_lshlrev_b32 v24, 16, v24
    v_add_f32 v16, v16, v24
    v_add_f32 v17, v17, v25
    v_cvt_pk_bf16_f32 v16, v16, v17
    s_cbranch_execz L_ftr
    buffer_store_dword v16, v9, s[32:35], s63 offen
    s_cmp_eq_u32 s62, 0
    s_cbranch_scc0 L_done
    s_mov_b64 exec, 1
    v_mov_b32 v17, s48
    buffer_store_dword v17, v8, s[40:43], 0 offen sc1
L_done:
L_end:
L_last:
    s_endpgm
.section .rodata,"a"
.p2align 6
.amdhsa_kernel parallel_sum__sliding_block_cached__swiglu_ffn__decode_kernel
  .amdhsa_next_free_vgpr 232
  .amdhsa_next_free_sgpr 102
  .amdhsa_accum_offset 232
  .amdhsa_group_segment_fixed_size 0
  .amdhsa_kernarg_size 96
  .amdhsa_user_sgpr_count 2
  .amdhsa_user_sgpr_kernarg_segment_ptr 1
  .amdhsa_system_sgpr_workgroup_id_x 1
.end_amdhsa_kernel
```
